```python
import torch

def _softmax(x, axis=-1):
    return torch.softmax(x, dim=axis)
def _gelu(x):
    return torch.nn.functional.gelu(x, approximate="tanh")
def _silu(x):
    return torch.nn.functional.silu(x)
def _sigmoid(x):
    return torch.sigmoid(x)
def _layernorm(x, axis=-1, eps=1e-5):
    m = x.mean(dim=axis, keepdim=True)
    v = x.var(dim=axis, keepdim=True, unbiased=False)
    return (x - m) / torch.sqrt(v + eps)
def _scatter_add(tgt, idx, src, axis=0):
    return tgt.clone().index_add_(axis, idx, src)
def _segment_sum(src, seg, n):
    out = torch.zeros((n,) + src.shape[1:], dtype=src.dtype)
    return out.index_add_(0, seg, src)
def _pad(x, pw):
    flat = tuple(v for pair in reversed(pw) for v in pair)
    return torch.nn.functional.pad(x, flat)

kernel_name = 'gated_mix__mha_block_cached__glu_gated_swiglu__decode'

def setup_inputs():

    _w = (lambda a: (lambda t: t.to(torch.bfloat16) if t.is_floating_point() else t)(torch.as_tensor(a)))
    def _A_setup():
        B, Sq, D = 1, 1, 512
        H, Sk, Dh = 32, 32768, 128
        return {
            "x": _w((lambda *s: torch.randn(*s, dtype=torch.bfloat16) * 0.05)(B, Sq, D)),
            "k_cache": _w((lambda *s: torch.randn(*s, dtype=torch.bfloat16) * 6.4)(B, H, Sk, Dh)),
            "v_cache": _w((lambda *s: torch.randn(*s, dtype=torch.bfloat16) * 0.2)(B, H, Sk, Dh)),
            "wq": _w((lambda *s: torch.randn(*s, dtype=torch.bfloat16) * 6.4)(D, H * Dh) * (D ** -0.5)),
            "wo": _w((lambda *s: torch.randn(*s, dtype=torch.bfloat16) * 0.2)(H * Dh, D) * ((H * Dh) ** -0.5)),
        }
    _A_in = _A_setup()

    def _B_setup():
        B, S, D, F = 1, 1, 512, 1792
        return {
            "x": _w((lambda *s: torch.randn(*s, dtype=torch.bfloat16) * 0.05)(B, S, D)),
            "w1": _w((lambda *s: torch.randn(*s, dtype=torch.bfloat16) * 0.8)(D, F) * (2.0 / D) ** 0.5),
            "w3": _w((lambda *s: torch.randn(*s, dtype=torch.bfloat16) * 0.8)(D, F) * (2.0 / D) ** 0.5),
            "w2": _w((lambda *s: torch.randn(*s, dtype=torch.bfloat16) * 0.8)(F, D) * (2.0 / F) ** 0.5),
        }
    _B_in = _B_setup()

    return {
        "A_x": _A_in["x"],
        "A_k_cache": _A_in["k_cache"],
        "A_v_cache": _A_in["v_cache"],
        "A_wq": _A_in["wq"],
        "A_wo": _A_in["wo"],
        "B_x": _B_in["x"],
        "B_w1": _B_in["w1"],
        "B_w3": _B_in["w3"],
        "B_w2": _B_in["w2"],
        "gate_w": _w((lambda *s: torch.randn(*s, dtype=torch.bfloat16) * 0.05)(512) * 16.0),
    }

def reference(A_x, A_k_cache, A_v_cache, A_wq, A_wo, B_x, B_w1, B_w3, B_w2, gate_w):
    def _A_ref(x, k_cache, v_cache, wq, wo):
        B, Sq, D = x.shape
        H, Dh = 32, 128
        q = (lambda x, *d: x.permute(*d))((x @ wq).reshape(B, Sq, H, Dh), 0, 2, 1, 3)
        scores = torch.einsum("bhqd,bhkd->bhqk", q, k_cache) * (Dh ** -0.5)
        p = _softmax(scores, axis=-1)
        o = torch.einsum("bhqk,bhkd->bhqd", p, v_cache)
        return (lambda x, *d: x.permute(*d))(o, 0, 2, 1, 3).reshape(B, Sq, H * Dh) @ wo

    def _B_ref(x, w1, w3, w2):
        gate = torch.einsum("bsd,df->bsf", x, w1)
        up = torch.einsum("bsd,df->bsf", x, w3)
        h = _silu(gate) * up
        out = torch.einsum("bsf,fd->bsd", h, w2)
        return out

    x = A_x
    g = _sigmoid((x * gate_w).sum(-1, keepdims=True))
    a = _A_ref(x, A_k_cache, A_v_cache, A_wq, A_wo)
    b = _B_ref(x, B_w1, B_w3, B_w2)
    return g * a + (1 - g) * b
```

```asm
; @launch grid=(256,1,1) block=(384,1,1) lds=156672
.amdgcn_target "amdgcn-amd-amdhsa--gfx950"
.text
.globl gated_mix__mha_block_cached__glu_gated_swiglu__decode_kernel
.p2align 8
.type gated_mix__mha_block_cached__glu_gated_swiglu__decode_kernel,@function
gated_mix__mha_block_cached__glu_gated_swiglu__decode_kernel:
    s_load_dwordx16 s[16:31], s[0:1], 0
    v_readfirstlane_b32 s3, v0
    s_cmpk_ge_u32 s2, 0x100
    s_cbranch_scc1 L_out
    v_and_b32 v0, 63, v0
    s_lshr_b32 s3, s3, 6
    s_and_b32 s42, s2, 31
    s_and_b32 s4, s2, 7
    s_lshl_b32 s4, s4, 2
    s_lshr_b32 s5, s42, 3
    s_or_b32 s4, s4, s5
    s_lshr_b32 s5, s2, 5
    s_cmp_lt_u32 s3, 4
    s_cbranch_scc1 L_low
    s_mov_b32 s47, 0x20000
    s_mov_b32 s51, s47
    s_cmp_eq_u32 s3, 4
    s_cbranch_scc1 L_b4
    s_lshr_b32 s6, s5, 1
    s_and_b32 s7, s5, 1
    s_lshl_b32 s10, s6, 3
    s_or_b32 s10, s10, s7
    s_lshl_b32 s10, s10, 17
    s_lshl_b32 s11, s4, 8
    s_or_b32 s10, s10, s11
    s_mov_b32 s43, s10
    s_movk_i32 s8, 0x4000
    s_movk_i32 s11, 0x2000
    s_lshl_b32 s12, s8, 4
    s_lshl_b32 s46, s8, 8
    s_mov_b32 s9, 4
    s_branch L_b
L_b4:
    s_cmp_lt_u32 s42, 28
    s_cbranch_scc0 L_bn
    s_lshl_b32 s43, s42, 7
    s_mul_i32 s10, s5, 28672
    s_add_u32 s10, s10, s43
    s_movk_i32 s8, 3584
    s_mov_b32 s11, 0
    s_lshl_b32 s12, s8, 6
    s_lshl_b32 s46, s8, 9
    s_mov_b32 s9, 3
L_b:
    s_add_u32 s11, s11, s10
    s_mov_b32 s50, s46
    v_lshrrev_b32 v2, s9, v0
    v_bfe_u32 v11, v0, 0, s9
    v_mul_u32_u24 v10, s12, v2
    v_lshl_add_u32 v3, v11, 4, v10
    s_cmp_eq_u32 s3, 4
    s_waitcnt lgkmcnt(0)
    s_cselect_b64 s[44:45], s[28:29], s[22:23]
    s_cselect_b64 s[48:49], s[30:31], s[22:23]
    buffer_load_dwordx4 v[128:131], v3, s[44:47], s10 offen
    buffer_load_dwordx4 v[132:135], v3, s[48:51], s11 offen
    s_add_u32 s10, s10, s8
    s_add_u32 s11, s11, s8
    buffer_load_dwordx4 v[136:139], v3, s[44:47], s10 offen
    buffer_load_dwordx4 v[140:143], v3, s[48:51], s11 offen
    s_add_u32 s10, s10, s8
    s_add_u32 s11, s11, s8
    buffer_load_dwordx4 v[144:147], v3, s[44:47], s10 offen
    buffer_load_dwordx4 v[148:151], v3, s[48:51], s11 offen
    s_add_u32 s10, s10, s8
    s_add_u32 s11, s11, s8
    buffer_load_dwordx4 v[152:155], v3, s[44:47], s10 offen
    buffer_load_dwordx4 v[156:159], v3, s[48:51], s11 offen
    s_add_u32 s10, s10, s8
    s_add_u32 s11, s11, s8
    buffer_load_dwordx4 v[160:163], v3, s[44:47], s10 offen
    buffer_load_dwordx4 v[164:167], v3, s[48:51], s11 offen
    s_add_u32 s10, s10, s8
    s_add_u32 s11, s11, s8
    buffer_load_dwordx4 v[168:171], v3, s[44:47], s10 offen
    buffer_load_dwordx4 v[172:175], v3, s[48:51], s11 offen
    s_add_u32 s10, s10, s8
    s_add_u32 s11, s11, s8
    buffer_load_dwordx4 v[176:179], v3, s[44:47], s10 offen
    buffer_load_dwordx4 v[180:183], v3, s[48:51], s11 offen
    s_add_u32 s10, s10, s8
    s_add_u32 s11, s11, s8
    buffer_load_dwordx4 v[184:187], v3, s[44:47], s10 offen
    buffer_load_dwordx4 v[188:191], v3, s[48:51], s11 offen
L_bn:
    s_load_dwordx8 s[32:39], s[0:1], 64
    s_load_dwordx2 s[40:41], s[0:1], 96
    v_mov_b32 v1, 147456
    s_cmp_eq_u32 s3, 4
    s_waitcnt vmcnt(10) lgkmcnt(0)
    s_barrier
    s_cbranch_scc1 L_aux
    s_branch L_q
L_out:
    s_endpgm
L_low:
    s_load_dwordx8 s[32:39], s[0:1], 64
    s_load_dwordx2 s[40:41], s[0:1], 96
    v_mov_b32 v1, 147456
    s_cmp_eq_u32 s3, 0
    s_cbranch_scc1 L_ld
    s_lshr_b32 s58, s2, 3
    s_sub_u32 s61, s3, 1
    s_or_b32 s58, s58, s61
    s_cbranch_scc0 L_cons
    s_waitcnt lgkmcnt(0)
    s_barrier
    s_branch L_c_nc
L_ld:
    s_setprio 3
    v_lshl_add_u32 v3, v0, 2, v1
    v_mov_b32 v7, 0
    ds_write_b32 v3, v7
    v_lshrrev_b32 v8, 4, v0
    v_lshlrev_b32 v9, 2, v8
    v_and_b32 v10, 15, v0
    v_xor_b32 v9, v9, v10
    v_lshlrev_b32 v8, 8, v8
    v_lshl_add_u32 v2, v9, 4, v8
    v_xor_b32 v3, 16, v2
    v_xor_b32 v4, 32, v2
    v_xor_b32 v5, 48, v2
    v_mov_b32 v12, 0
    v_mov_b32 v14, 0
    s_lshl_b32 s7, s2, 6
    v_or_b32 v9, s7, v0
    s_mov_b32 s64, 0x19400
    s_mov_b32 s65, 0x210800
    s_mov_b32 s56, 0x238000
    s_mov_b32 s57, 0x19000
    v_bfe_i32 v8, v9, 0, 1
    v_and_b32 v8, 0x203000, v8
    v_xor_b32 v14, v14, v8
    v_bfe_i32 v8, v9, 1, 1
    v_and_b32 v8, 0x748c00, v8
    v_xor_b32 v14, v14, v8
    v_bfe_i32 v8, v9, 2, 1
    v_and_b32 v8, 0x495400, v8
    v_xor_b32 v14, v14, v8
    v_bfe_i32 v8, v9, 3, 1
    v_and_b32 v8, 0x470800, v8
    v_xor_b32 v14, v14, v8
    v_bfe_i32 v8, v9, 4, 1
    v_and_b32 v8, 0x728c00, v8
    v_xor_b32 v14, v14, v8
    v_bfe_i32 v8, v9, 5, 1
    v_and_b32 v8, 0x10a400, v8
    v_xor_b32 v14, v14, v8
    v_bfe_i32 v8, v9, 6, 1
    v_and_b32 v8, 0x249a400, v8
    v_xor_b32 v14, v14, v8
    v_bfe_i32 v8, v9, 7, 1
    v_and_b32 v8, 0x46a9000, v8
    v_xor_b32 v14, v14, v8
    v_bfe_i32 v8, v9, 8, 1
    v_and_b32 v8, 0x801ec00, v8
    v_xor_b32 v14, v14, v8
    v_bfe_i32 v8, v9, 9, 1
    v_and_b32 v8, 0xac2400, v8
    v_xor_b32 v14, v14, v8
    v_bfe_i32 v8, v9, 10, 1
    v_and_b32 v8, 0x15b3c00, v8
    v_xor_b32 v14, v14, v8
    v_bfe_i32 v8, v9, 11, 1
    v_and_b32 v8, 0x11000, v8
    v_xor_b32 v14, v14, v8
    v_bfe_i32 v8, v9, 12, 1
    v_and_b32 v8, 0x231400, v8
    v_xor_b32 v14, v14, v8
    v_bfe_i32 v8, v9, 13, 1
    v_and_b32 v8, 0x14000, v8
    v_xor_b32 v14, v14, v8
    s_mov_b32 s9, 0
    s_mov_b32 s10, 0
    s_mov_b32 s11, 9
    s_mov_b32 s46, 0x10000000
    s_mov_b32 s47, 0x20000
    s_waitcnt lgkmcnt(0)
    s_mov_b32 s44, s18
    s_mov_b32 s45, s19
    s_barrier
L_ld_slot:
    s_cmp_lt_u32 s9, s11
    s_cbranch_scc0 L_ld_full
L_ld_go:
    s_waitcnt lgkmcnt(1)
    v_readfirstlane_b32 s15, v12
    s_and_b32 s12, s9, 63
    v_readlane_b32 s13, v14, s12
    s_brev_b32 s12, s9
    s_lshr_b32 s12, s12, 29
    s_add_u32 s15, s15, s12
    s_add_u32 s9, s9, 1
    s_mov_b32 s12, 0
    s_cmp_lt_i32 s15, 0
    s_cbranch_scc1 L_ld_lo
    s_cmp_ge_i32 s15, 8
    s_cbranch_scc1 L_ld_hi
L_ld_f24:
    s_add_u32 m0, s10, s12
    s_mov_b32 s14, s13
    s_bitcmp1_b32 s12, 12
    s_cselect_b32 s8, s65, s64
    s_xor_b32 s13, s13, s8
    ds_read_b32 v12, v1 offset:8
    s_waitcnt vmcnt(23)
    buffer_load_dwordx4 v2, s[44:47], s14 offen nt lds
    s_addk_i32 m0, 0x400
    s_xor_b32 s14, s14, s56
    s_waitcnt vmcnt(23)
    buffer_load_dwordx4 v3, s[44:47], s14 offen nt lds
    s_addk_i32 m0, 0x400
    s_xor_b32 s14, s14, s57
    s_waitcnt vmcnt(23)
    buffer_load_dwordx4 v4, s[44:47], s14 offen nt lds
    s_addk_i32 m0, 0x400
    s_xor_b32 s14, s14, s56
    s_waitcnt vmcnt(23)
    v_add_u32 v8, -5, v7
    ds_write_b32 v1, v8 offset:0
    buffer_load_dwordx4 v5, s[44:47], s14 offen nt lds
    v_add_u32 v7, 1, v7
    s_addk_i32 s12, 0x1000
    s_cmpk_lt_u32 s12, 0x4000
    s_cbranch_scc1 L_ld_f24
L_ld_adv:
    s_add_u32 s10, s10, 16384
    s_cmp_eq_u32 s10, 147456
    s_cselect_b32 s10, 0, s10
    s_and_b32 s12, s9, 63
    s_cbranch_scc1 L_ld_slot
    s_branch L_ld_turn
L_padB_0:
    s_branch L_padB_1
L_ld_full:
    s_mov_b32 s60, 0
L_rw_1:
    ds_read_b96 v[8:10], v1 offset:16
    s_waitcnt lgkmcnt(0)
    v_add_u32 v9, 1, v9
    v_add_u32 v10, 2, v10
    v_min3_u32 v8, v8, v9, v10
    s_nop 0
    v_readfirstlane_b32 s11, v8
    s_add_u32 s11, s11, 9
    s_cmp_lt_u32 s9, s11
    s_cbranch_scc1 L_ld_go
    s_add_u32 s60, s60, 1
    s_cmp_lt_u32 s60, 1000000
    s_cbranch_scc1 L_rw_1
    s_endpgm
L_padB_1:
    s_branch L_padB_2
L_ld_lo:
    s_cmp_lt_i32 s15, -8
    s_cbranch_scc1 L_ld_t22
L_ld_f23:
    s_add_u32 m0, s10, s12
    s_mov_b32 s14, s13
    s_bitcmp1_b32 s12, 12
    s_cselect_b32 s8, s65, s64
    s_xor_b32 s13, s13, s8
    ds_read_b32 v12, v1 offset:8
    s_waitcnt vmcnt(22)
    buffer_load_dwordx4 v2, s[44:47], s14 offen nt lds
    s_addk_i32 m0, 0x400
    s_xor_b32 s14, s14, s56
    s_waitcnt vmcnt(22)
    buffer_load_dwordx4 v3, s[44:47], s14 offen nt lds
    s_addk_i32 m0, 0x400
    s_xor_b32 s14, s14, s57
    s_waitcnt vmcnt(22)
    v_add_u32 v8, -5, v7
    ds_write_b32 v1, v8 offset:0
    buffer_load_dwordx4 v4, s[44:47], s14 offen nt lds
    s_addk_i32 m0, 0x400
    s_xor_b32 s14, s14, s56
    s_waitcnt vmcnt(22)
    buffer_load_dwordx4 v5, s[44:47], s14 offen nt lds
    v_add_u32 v7, 1, v7
    s_addk_i32 s12, 0x1000
    s_cmpk_lt_u32 s12, 0x4000
    s_cbranch_scc1 L_ld_f23
    s_branch L_ld_adv
L_padB_2:
    s_branch L_padB_3
L_ld_t22:
    s_cmp_lt_i32 s15, -16
    s_cbranch_scc1 L_ld_t21
L_ld_f22:
    s_add_u32 m0, s10, s12
    s_mov_b32 s14, s13
    s_bitcmp1_b32 s12, 12
    s_cselect_b32 s8, s65, s64
    s_xor_b32 s13, s13, s8
    ds_read_b32 v12, v1 offset:8
    s_waitcnt vmcnt(21)
    buffer_load_dwordx4 v2, s[44:47], s14 offen nt lds
    s_addk_i32 m0, 0x400
    s_xor_b32 s14, s14, s56
    s_waitcnt vmcnt(21)
    v_add_u32 v8, -5, v7
    ds_write_b32 v1, v8 offset:0
    buffer_load_dwordx4 v3, s[44:47], s14 offen nt lds
    s_addk_i32 m0, 0x400
    s_xor_b32 s14, s14, s57
    s_waitcnt vmcnt(21)
    buffer_load_dwordx4 v4, s[44:47], s14 offen nt lds
    s_addk_i32 m0, 0x400
    s_xor_b32 s14, s14, s56
    s_waitcnt vmcnt(21)
    buffer_load_dwordx4 v5, s[44:47], s14 offen nt lds
    v_add_u32 v7, 1, v7
    s_addk_i32 s12, 0x1000
    s_cmpk_lt_u32 s12, 0x4000
    s_cbranch_scc1 L_ld_f22
    s_branch L_ld_adv
L_padB_3:
    s_branch L_padB_4
L_ld_t21:
    s_cmp_lt_i32 s15, -24
    s_cbranch_scc1 L_ld_t20
L_ld_f21:
    s_add_u32 m0, s10, s12
    s_mov_b32 s14, s13
    s_bitcmp1_b32 s12, 12
    s_cselect_b32 s8, s65, s64
    s_xor_b32 s13, s13, s8
    ds_read_b32 v12, v1 offset:8
    s_waitcnt vmcnt(20)
    v_add_u32 v8, -5, v7
    ds_write_b32 v1, v8 offset:0
    buffer_load_dwordx4 v2, s[44:47], s14 offen nt lds
    s_addk_i32 m0, 0x400
    s_xor_b32 s14, s14, s56
    s_waitcnt vmcnt(20)
    buffer_load_dwordx4 v3, s[44:47], s14 offen nt lds
    s_addk_i32 m0, 0x400
    s_xor_b32 s14, s14, s57
    s_waitcnt vmcnt(20)
    buffer_load_dwordx4 v4, s[44:47], s14 offen nt lds
    s_addk_i32 m0, 0x400
    s_xor_b32 s14, s14, s56
    s_waitcnt vmcnt(20)
    buffer_load_dwordx4 v5, s[44:47], s14 offen nt lds
    v_add_u32 v7, 1, v7
    s_addk_i32 s12, 0x1000
    s_cmpk_lt_u32 s12, 0x4000
    s_cbranch_scc1 L_ld_f21
    s_branch L_ld_adv
L_padB_4:
    s_branch L_padB_5
L_ld_t20:
    s_cmp_lt_i32 s15, -32
    s_cbranch_scc1 L_ld_t19
L_ld_f20:
    s_add_u32 m0, s10, s12
    s_mov_b32 s14, s13
    s_bitcmp1_b32 s12, 12
    s_cselect_b32 s8, s65, s64
    s_xor_b32 s13, s13, s8
    ds_read_b32 v12, v1 offset:8
    s_waitcnt vmcnt(19)
    buffer_load_dwordx4 v2, s[44:47], s14 offen nt lds
    s_addk_i32 m0, 0x400
    s_xor_b32 s14, s14, s56
    s_waitcnt vmcnt(19)
    buffer_load_dwordx4 v3, s[44:47], s14 offen nt lds
    s_addk_i32 m0, 0x400
    s_xor_b32 s14, s14, s57
    s_waitcnt vmcnt(19)
    buffer_load_dwordx4 v4, s[44:47], s14 offen nt lds
    s_addk_i32 m0, 0x400
    s_xor_b32 s14, s14, s56
    s_waitcnt vmcnt(19)
    v_add_u32 v8, -4, v7
    ds_write_b32 v1, v8 offset:0
    buffer_load_dwordx4 v5, s[44:47], s14 offen nt lds
    v_add_u32 v7, 1, v7
    s_addk_i32 s12, 0x1000
    s_cmpk_lt_u32 s12, 0x4000
    s_cbranch_scc1 L_ld_f20
    s_branch L_ld_adv
L_padB_5:
    s_branch L_padB_6
L_ld_t19:
    s_cmp_lt_i32 s15, -40
    s_cbranch_scc1 L_ld_t18
L_ld_f19:
    s_add_u32 m0, s10, s12
    s_mov_b32 s14, s13
    s_bitcmp1_b32 s12, 12
    s_cselect_b32 s8, s65, s64
    s_xor_b32 s13, s13, s8
    ds_read_b32 v12, v1 offset:8
    s_waitcnt vmcnt(18)
    buffer_load_dwordx4 v2, s[44:47], s14 offen nt lds
    s_addk_i32 m0, 0x400
    s_xor_b32 s14, s14, s56
    s_waitcnt vmcnt(18)
    buffer_load_dwordx4 v3, s[44:47], s14 offen nt lds
    s_addk_i32 m0, 0x400
    s_xor_b32 s14, s14, s57
    s_waitcnt vmcnt(18)
    v_add_u32 v8, -4, v7
    ds_write_b32 v1, v8 offset:0
    buffer_load_dwordx4 v4, s[44:47], s14 offen nt lds
    s_addk_i32 m0, 0x400
    s_xor_b32 s14, s14, s56
    s_waitcnt vmcnt(18)
    buffer_load_dwordx4 v5, s[44:47], s14 offen nt lds
    v_add_u32 v7, 1, v7
    s_addk_i32 s12, 0x1000
    s_cmpk_lt_u32 s12, 0x4000
    s_cbranch_scc1 L_ld_f19
    s_branch L_ld_adv
L_padB_6:
    s_branch L_padB_7
L_ld_t18:
    s_cmp_lt_i32 s15, -48
    s_cbranch_scc1 L_ld_t17
L_ld_f18:
    s_add_u32 m0, s10, s12
    s_mov_b32 s14, s13
    s_bitcmp1_b32 s12, 12
    s_cselect_b32 s8, s65, s64
    s_xor_b32 s13, s13, s8
    ds_read_b32 v12, v1 offset:8
    s_waitcnt vmcnt(17)
    buffer_load_dwordx4 v2, s[44:47], s14 offen nt lds
    s_addk_i32 m0, 0x400
    s_xor_b32 s14, s14, s56
    s_waitcnt vmcnt(17)
    v_add_u32 v8, -4, v7
    ds_write_b32 v1, v8 offset:0
    buffer_load_dwordx4 v3, s[44:47], s14 offen nt lds
    s_addk_i32 m0, 0x400
    s_xor_b32 s14, s14, s57
    s_waitcnt vmcnt(17)
    buffer_load_dwordx4 v4, s[44:47], s14 offen nt lds
    s_addk_i32 m0, 0x400
    s_xor_b32 s14, s14, s56
    s_waitcnt vmcnt(17)
    buffer_load_dwordx4 v5, s[44:47], s14 offen nt lds
    v_add_u32 v7, 1, v7
    s_addk_i32 s12, 0x1000
    s_cmpk_lt_u32 s12, 0x4000
    s_cbranch_scc1 L_ld_f18
    s_branch L_ld_adv
L_padB_7:
    s_branch L_padB_8
L_ld_t17:
L_ld_f17:
    s_add_u32 m0, s10, s12
    s_mov_b32 s14, s13
    s_bitcmp1_b32 s12, 12
    s_cselect_b32 s8, s65, s64
    s_xor_b32 s13, s13, s8
    ds_read_b32 v12, v1 offset:8
    s_waitcnt vmcnt(16)
    v_add_u32 v8, -4, v7
    ds_write_b32 v1, v8 offset:0
    buffer_load_dwordx4 v2, s[44:47], s14 offen nt lds
    s_addk_i32 m0, 0x400
    s_xor_b32 s14, s14, s56
    s_waitcnt vmcnt(16)
    buffer_load_dwordx4 v3, s[44:47], s14 offen nt lds
    s_addk_i32 m0, 0x400
    s_xor_b32 s14, s14, s57
    s_waitcnt vmcnt(16)
    buffer_load_dwordx4 v4, s[44:47], s14 offen nt lds
    s_addk_i32 m0, 0x400
    s_xor_b32 s14, s14, s56
    s_waitcnt vmcnt(16)
    buffer_load_dwordx4 v5, s[44:47], s14 offen nt lds
    v_add_u32 v7, 1, v7
    s_addk_i32 s12, 0x1000
    s_cmpk_lt_u32 s12, 0x4000
    s_cbranch_scc1 L_ld_f17
    s_branch L_ld_adv
L_padB_8:
    s_branch L_pad_back
L_ld_hi:
    s_cmp_ge_i32 s15, 16
    s_cbranch_scc1 L_ld_t26
L_ld_f25:
    s_add_u32 m0, s10, s12
    s_mov_b32 s14, s13
    s_bitcmp1_b32 s12, 12
    s_cselect_b32 s8, s65, s64
    s_xor_b32 s13, s13, s8
    ds_read_b32 v12, v1 offset:8
    s_waitcnt vmcnt(24)
    v_add_u32 v8, -6, v7
    ds_write_b32 v1, v8 offset:0
    buffer_load_dwordx4 v2, s[44:47], s14 offen nt lds
    s_addk_i32 m0, 0x400
    s_xor_b32 s14, s14, s56
    s_waitcnt vmcnt(24)
    buffer_load_dwordx4 v3, s[44:47], s14 offen nt lds
    s_addk_i32 m0, 0x400
    s_xor_b32 s14, s14, s57
    s_waitcnt vmcnt(24)
    buffer_load_dwordx4 v4, s[44:47], s14 offen nt lds
    s_addk_i32 m0, 0x400
    s_xor_b32 s14, s14, s56
    s_waitcnt vmcnt(24)
    buffer_load_dwordx4 v5, s[44:47], s14 offen nt lds
    v_add_u32 v7, 1, v7
    s_addk_i32 s12, 0x1000
    s_cmpk_lt_u32 s12, 0x4000
    s_cbranch_scc1 L_ld_f25
    s_branch L_ld_adv
L_padC_4:
    s_branch L_padC_5
L_ld_t26:
    s_cmp_ge_i32 s15, 24
    s_cbranch_scc1 L_ld_t27
L_ld_f26:
    s_add_u32 m0, s10, s12
    s_mov_b32 s14, s13
    s_bitcmp1_b32 s12, 12
    s_cselect_b32 s8, s65, s64
    s_xor_b32 s13, s13, s8
    ds_read_b32 v12, v1 offset:8
    s_waitcnt vmcnt(25)
    buffer_load_dwordx4 v2, s[44:47], s14 offen nt lds
    s_addk_i32 m0, 0x400
    s_xor_b32 s14, s14, s56
    s_waitcnt vmcnt(25)
    v_add_u32 v8, -6, v7
    ds_write_b32 v1, v8 offset:0
    buffer_load_dwordx4 v3, s[44:47], s14 offen nt lds
    s_addk_i32 m0, 0x400
    s_xor_b32 s14, s14, s57
    s_waitcnt vmcnt(25)
    buffer_load_dwordx4 v4, s[44:47], s14 offen nt lds
    s_addk_i32 m0, 0x400
    s_xor_b32 s14, s14, s56
    s_waitcnt vmcnt(25)
    buffer_load_dwordx4 v5, s[44:47], s14 offen nt lds
    v_add_u32 v7, 1, v7
    s_addk_i32 s12, 0x1000
    s_cmpk_lt_u32 s12, 0x4000
    s_cbranch_scc1 L_ld_f26
    s_branch L_ld_adv
L_padC_5:
    s_branch L_pad_back
L_ld_t27:
    s_cmp_ge_i32 s15, 32
    s_cbranch_scc1 L_ld_t28
L_ld_f27:
    s_add_u32 m0, s10, s12
    s_mov_b32 s14, s13
    s_bitcmp1_b32 s12, 12
    s_cselect_b32 s8, s65, s64
    s_xor_b32 s13, s13, s8
    ds_read_b32 v12, v1 offset:8
    s_waitcnt vmcnt(26)
    buffer_load_dwordx4 v2, s[44:47], s14 offen nt lds
    s_addk_i32 m0, 0x400
    s_xor_b32 s14, s14, s56
    s_waitcnt vmcnt(26)
    buffer_load_dwordx4 v3, s[44:47], s14 offen nt lds
    s_addk_i32 m0, 0x400
    s_xor_b32 s14, s14, s57
    s_waitcnt vmcnt(26)
    v_add_u32 v8, -6, v7
    ds_write_b32 v1, v8 offset:0
    buffer_load_dwordx4 v4, s[44:47], s14 offen nt lds
    s_addk_i32 m0, 0x400
    s_xor_b32 s14, s14, s56
    s_waitcnt vmcnt(26)
    buffer_load_dwordx4 v5, s[44:47], s14 offen nt lds
    v_add_u32 v7, 1, v7
    s_addk_i32 s12, 0x1000
    s_cmpk_lt_u32 s12, 0x4000
    s_cbranch_scc1 L_ld_f27
    s_branch L_ld_adv
L_padF_0:
    s_branch L_padF_1
L_ld_t28:
    s_cmp_ge_i32 s15, 40
    s_cbranch_scc1 L_ld_t29
L_ld_f28:
    s_add_u32 m0, s10, s12
    s_mov_b32 s14, s13
    s_bitcmp1_b32 s12, 12
    s_cselect_b32 s8, s65, s64
    s_xor_b32 s13, s13, s8
    ds_read_b32 v12, v1 offset:8
    s_waitcnt vmcnt(27)
    buffer_load_dwordx4 v2, s[44:47], s14 offen nt lds
    s_addk_i32 m0, 0x400
    s_xor_b32 s14, s14, s56
    s_waitcnt vmcnt(27)
    buffer_load_dwordx4 v3, s[44:47], s14 offen nt lds
    s_addk_i32 m0, 0x400
    s_xor_b32 s14, s14, s57
    s_waitcnt vmcnt(27)
    buffer_load_dwordx4 v4, s[44:47], s14 offen nt lds
    s_addk_i32 m0, 0x400
    s_xor_b32 s14, s14, s56
    s_waitcnt vmcnt(27)
    v_add_u32 v8, -6, v7
    ds_write_b32 v1, v8 offset:0
    buffer_load_dwordx4 v5, s[44:47], s14 offen nt lds
    v_add_u32 v7, 1, v7
    s_addk_i32 s12, 0x1000
    s_cmpk_lt_u32 s12, 0x4000
    s_cbranch_scc1 L_ld_f28
    s_branch L_ld_adv
L_padF_1:
    s_branch L_padF_2
L_ld_t29:
    s_cmp_ge_i32 s15, 48
    s_cbranch_scc1 L_ld_t30
L_ld_f29:
    s_add_u32 m0, s10, s12
    s_mov_b32 s14, s13
    s_bitcmp1_b32 s12, 12
    s_cselect_b32 s8, s65, s64
    s_xor_b32 s13, s13, s8
    ds_read_b32 v12, v1 offset:8
    s_waitcnt vmcnt(28)
    v_add_u32 v8, -7, v7
    ds_write_b32 v1, v8 offset:0
    buffer_load_dwordx4 v2, s[44:47], s14 offen nt lds
    s_addk_i32 m0, 0x400
    s_xor_b32 s14, s14, s56
    s_waitcnt vmcnt(28)
    buffer_load_dwordx4 v3, s[44:47], s14 offen nt lds
    s_addk_i32 m0, 0x400
    s_xor_b32 s14, s14, s57
    s_waitcnt vmcnt(28)
    buffer_load_dwordx4 v4, s[44:47], s14 offen nt lds
    s_addk_i32 m0, 0x400
    s_xor_b32 s14, s14, s56
    s_waitcnt vmcnt(28)
    buffer_load_dwordx4 v5, s[44:47], s14 offen nt lds
    v_add_u32 v7, 1, v7
    s_addk_i32 s12, 0x1000
    s_cmpk_lt_u32 s12, 0x4000
    s_cbranch_scc1 L_ld_f29
    s_branch L_ld_adv
L_padF_2:
    s_branch L_padF_3
L_ld_t30:
L_ld_f30:
    s_add_u32 m0, s10, s12
    s_mov_b32 s14, s13
    s_bitcmp1_b32 s12, 12
    s_cselect_b32 s8, s65, s64
    s_xor_b32 s13, s13, s8
    ds_read_b32 v12, v1 offset:8
    s_waitcnt vmcnt(29)
    buffer_load_dwordx4 v2, s[44:47], s14 offen nt lds
    s_addk_i32 m0, 0x400
    s_xor_b32 s14, s14, s56
    s_waitcnt vmcnt(29)
    v_add_u32 v8, -7, v7
    ds_write_b32 v1, v8 offset:0
    buffer_load_dwordx4 v3, s[44:47], s14 offen nt lds
    s_addk_i32 m0, 0x400
    s_xor_b32 s14, s14, s57
    s_waitcnt vmcnt(29)
    buffer_load_dwordx4 v4, s[44:47], s14 offen nt lds
    s_addk_i32 m0, 0x400
    s_xor_b32 s14, s14, s56
    s_waitcnt vmcnt(29)
    buffer_load_dwordx4 v5, s[44:47], s14 offen nt lds
    v_add_u32 v7, 1, v7
    s_addk_i32 s12, 0x1000
    s_cmpk_lt_u32 s12, 0x4000
    s_cbranch_scc1 L_ld_f30
    s_branch L_ld_adv
L_padF_3:
    s_branch L_padF_4
L_ld_full2:
    s_mov_b32 s60, 0
L_rw_2:
    ds_read_b96 v[8:10], v1 offset:16
    s_waitcnt lgkmcnt(0)
    v_add_u32 v9, 1, v9
    v_add_u32 v10, 2, v10
    v_min3_u32 v8, v8, v9, v10
    s_nop 0
    v_readfirstlane_b32 s11, v8
    s_add_u32 s11, s11, 9
    s_cmp_lt_u32 s9, s11
    s_cbranch_scc1 L_ld_go2
    s_add_u32 s60, s60, 1
    s_cmp_lt_u32 s60, 1000000
    s_cbranch_scc1 L_rw_2
    s_endpgm
L_padF_4:
    s_branch L_padF_5
L_ld_turn:
    s_mov_b32 s44, s20
    s_mov_b32 s45, s21
    v_lshlrev_b32 v2, 4, v0
    v_mov_b32 v3, v2
    v_mov_b32 v4, v2
    v_mov_b32 v5, v2
    s_cmp_eq_u32 s9, 64
    s_cbranch_scc1 L_ld_slot
    v_lshrrev_b32 v8, 3, v0
    v_and_b32 v9, 7, v0
    v_lshlrev_b32 v8, 10, v8
    v_lshl_add_u32 v2, v9, 4, v8
    s_lshl_b32 s13, s4, 17
    s_lshl_b32 s14, s5, 7
    s_add_u32 s13, s13, s14
    s_mov_b32 s44, s24
    s_mov_b32 s45, s25
    s_mov_b32 s46, 0x400000
    s_cmp_lt_u32 s9, s11
    s_cbranch_scc0 L_ld_full2
L_ld_go2:
    s_waitcnt vmcnt(24)
    v_add_u32 v8, -6, v7
    ds_write_b32 v1, v8 offset:0
    s_waitcnt vmcnt(20)
    v_add_u32 v8, -5, v7
    ds_write_b32 v1, v8 offset:0
    s_waitcnt vmcnt(16)
    v_add_u32 v8, -4, v7
    ds_write_b32 v1, v8 offset:0
    s_add_u32 m0, s10, 0
    s_waitcnt vmcnt(15)
    buffer_load_dwordx4 v2, s[44:47], s13 offen nt lds
    s_addk_i32 s13, 0x2000
    s_add_u32 m0, s10, 1024
    s_waitcnt vmcnt(15)
    buffer_load_dwordx4 v2, s[44:47], s13 offen nt lds
    s_addk_i32 s13, 0x2000
    s_add_u32 m0, s10, 2048
    s_waitcnt vmcnt(15)
    buffer_load_dwordx4 v2, s[44:47], s13 offen nt lds
    s_addk_i32 s13, 0x2000
    s_add_u32 m0, s10, 3072
    s_waitcnt vmcnt(15)
    v_add_u32 v8, -3, v7
    ds_write_b32 v1, v8 offset:0
    buffer_load_dwordx4 v2, s[44:47], s13 offen nt lds
    s_addk_i32 s13, 0x2000
    s_add_u32 m0, s10, 4096
    s_waitcnt vmcnt(15)
    buffer_load_dwordx4 v2, s[44:47], s13 offen nt lds
    s_addk_i32 s13, 0x2000
    s_add_u32 m0, s10, 5120
    s_waitcnt vmcnt(15)
    buffer_load_dwordx4 v2, s[44:47], s13 offen nt lds
    s_addk_i32 s13, 0x2000
    s_add_u32 m0, s10, 6144
    s_waitcnt vmcnt(15)
    buffer_load_dwordx4 v2, s[44:47], s13 offen nt lds
    s_addk_i32 s13, 0x2000
    s_add_u32 m0, s10, 7168
    s_waitcnt vmcnt(15)
    v_add_u32 v8, -2, v7
    ds_write_b32 v1, v8 offset:0
    buffer_load_dwordx4 v2, s[44:47], s13 offen nt lds
    s_addk_i32 s13, 0x2000
    s_add_u32 m0, s10, 8192
    s_waitcnt vmcnt(15)
    buffer_load_dwordx4 v2, s[44:47], s13 offen nt lds
    s_addk_i32 s13, 0x2000
    s_add_u32 m0, s10, 9216
    s_waitcnt vmcnt(15)
    buffer_load_dwordx4 v2, s[44:47], s13 offen nt lds
    s_addk_i32 s13, 0x2000
    s_add_u32 m0, s10, 10240
    s_waitcnt vmcnt(15)
    buffer_load_dwordx4 v2, s[44:47], s13 offen nt lds
    s_addk_i32 s13, 0x2000
    s_add_u32 m0, s10, 11264
    s_waitcnt vmcnt(15)
    v_add_u32 v8, -1, v7
    ds_write_b32 v1, v8 offset:0
    buffer_load_dwordx4 v2, s[44:47], s13 offen nt lds
    s_addk_i32 s13, 0x2000
    s_add_u32 m0, s10, 12288
    s_waitcnt vmcnt(15)
    buffer_load_dwordx4 v2, s[44:47], s13 offen nt lds
    s_addk_i32 s13, 0x2000
    s_add_u32 m0, s10, 13312
    s_waitcnt vmcnt(15)
    buffer_load_dwordx4 v2, s[44:47], s13 offen nt lds
    s_addk_i32 s13, 0x2000
    s_add_u32 m0, s10, 14336
    s_waitcnt vmcnt(15)
    buffer_load_dwordx4 v2, s[44:47], s13 offen nt lds
    s_addk_i32 s13, 0x2000
    s_add_u32 m0, s10, 15360
    s_waitcnt vmcnt(15)
    v_add_u32 v8, 0, v7
    ds_write_b32 v1, v8 offset:0
    buffer_load_dwordx4 v2, s[44:47], s13 offen nt lds
    s_addk_i32 s13, 0x2000
    s_waitcnt vmcnt(8)
    v_add_u32 v8, 2, v7
    ds_write_b32 v1, v8 offset:0
    s_waitcnt vmcnt(0)
    v_add_u32 v8, 4, v7
    ds_write_b32 v1, v8 offset:0
    s_endpgm
L_padF_5:
    s_branch L_k_nb
L_q:
    s_lshl_b32 s61, s6, 8
    s_lshl_b32 s62, s7, 5
    s_or_b32 s61, s61, s62
    v_lshl_add_u32 v2, v2, 6, s61
    v_xor_b32 v4, 0, v2
    global_load_dwordx4 v[16:19], v4, s[16:17]
    v_xor_b32 v4, 16, v2
    global_load_dwordx4 v[20:23], v4, s[16:17]
    v_xor_b32 v4, 32, v2
    global_load_dwordx4 v[24:27], v4, s[16:17]
    v_xor_b32 v4, 48, v2
    global_load_dwordx4 v[28:31], v4, s[16:17]
    v_and_b32 v8, 1, v0
    v_cmp_eq_u32 vcc, 1, v8
    v_mov_b32 v9, 0x0c0c0100
    v_mov_b32 v10, 0x01000c0c
    v_mov_b32 v11, 0x0c0c0302
    v_mov_b32 v12, 0x03020c0c
    v_mov_b32 v13, 0x0c0c0c0c
    v_bfe_u32 v8, v0, 1, 2
    v_cndmask_b32 v9, v9, v10, vcc
    v_cndmask_b32 v11, v11, v12, vcc
    v_cmp_eq_u32 vcc, 0, v8
    s_nop 1
    v_cndmask_b32 v240, v13, v9, vcc
    v_cndmask_b32 v244, v13, v11, vcc
    v_cmp_eq_u32 vcc, 1, v8
    s_nop 1
    v_cndmask_b32 v241, v13, v9, vcc
    v_cndmask_b32 v245, v13, v11, vcc
    v_cmp_eq_u32 vcc, 2, v8
    s_nop 1
    v_cndmask_b32 v242, v13, v9, vcc
    v_cndmask_b32 v246, v13, v11, vcc
    v_cmp_eq_u32 vcc, 3, v8
    s_nop 1
    v_cndmask_b32 v243, v13, v9, vcc
    v_cndmask_b32 v247, v13, v11, vcc
    s_waitcnt vmcnt(0)
    v_perm_b32 v48, v16, v16, v240
    v_perm_b32 v49, v16, v16, v241
    v_perm_b32 v50, v16, v16, v242
    v_perm_b32 v51, v16, v16, v243
    s_waitcnt vmcnt(0)
    s_xor_b32 s62, s43, 131072
    buffer_load_dwordx4 v[192:195], v3, s[44:47], s62 offen
    s_xor_b32 s62, s43, 139264
    buffer_load_dwordx4 v[196:199], v3, s[44:47], s62 offen
    s_xor_b32 s62, s43, 147456
    buffer_load_dwordx4 v[200:203], v3, s[44:47], s62 offen
    s_xor_b32 s62, s43, 155648
    buffer_load_dwordx4 v[204:207], v3, s[44:47], s62 offen
    s_xor_b32 s62, s43, 163840
    buffer_load_dwordx4 v[208:211], v3, s[44:47], s62 offen
    s_xor_b32 s62, s43, 172032
    buffer_load_dwordx4 v[212:215], v3, s[44:47], s62 offen
    s_xor_b32 s62, s43, 180224
    buffer_load_dwordx4 v[216:219], v3, s[44:47], s62 offen
    s_xor_b32 s62, s43, 188416
    buffer_load_dwordx4 v[220:223], v3, s[44:47], s62 offen
    v_mfma_f32_16x16x32_bf16 v[12:15], v[48:51], v[128:131], 0
    v_perm_b32 v52, v16, v16, v244
    v_perm_b32 v53, v16, v16, v245
    v_perm_b32 v54, v16, v16, v246
    v_perm_b32 v55, v16, v16, v247
    s_waitcnt vmcnt(8)
    s_nop 0
    v_mfma_f32_16x16x32_bf16 v[12:15], v[52:55], v[132:135], v[12:15]
    v_perm_b32 v56, v17, v17, v240
    v_perm_b32 v57, v17, v17, v241
    v_perm_b32 v58, v17, v17, v242
    v_perm_b32 v59, v17, v17, v243
    s_waitcnt vmcnt(8)
    s_nop 0
    v_mfma_f32_16x16x32_bf16 v[12:15], v[56:59], v[136:139], v[12:15]
    v_perm_b32 v60, v17, v17, v244
    v_perm_b32 v61, v17, v17, v245
    v_perm_b32 v62, v17, v17, v246
    v_perm_b32 v63, v17, v17, v247
    s_waitcnt vmcnt(8)
    s_nop 0
    v_mfma_f32_16x16x32_bf16 v[12:15], v[60:63], v[140:143], v[12:15]
    v_perm_b32 v64, v18, v18, v240
    v_perm_b32 v65, v18, v18, v241
    v_perm_b32 v66, v18, v18, v242
    v_perm_b32 v67, v18, v18, v243
    s_waitcnt vmcnt(8)
    s_nop 0
    v_mfma_f32_16x16x32_bf16 v[12:15], v[64:67], v[144:147], v[12:15]
    v_perm_b32 v68, v18, v18, v244
    v_perm_b32 v69, v18, v18, v245
    v_perm_b32 v70, v18, v18, v246
    v_perm_b32 v71, v18, v18, v247
    s_waitcnt vmcnt(8)
    s_nop 0
    v_mfma_f32_16x16x32_bf16 v[12:15], v[68:71], v[148:151], v[12:15]
    v_perm_b32 v72, v19, v19, v240
    v_perm_b32 v73, v19, v19, v241
    v_perm_b32 v74, v19, v19, v242
    v_perm_b32 v75, v19, v19, v243
    s_waitcnt vmcnt(8)
    s_nop 0
    v_mfma_f32_16x16x32_bf16 v[12:15], v[72:75], v[152:155], v[12:15]
    v_perm_b32 v76, v19, v19, v244
    v_perm_b32 v77, v19, v19, v245
    v_perm_b32 v78, v19, v19, v246
    v_perm_b32 v79, v19, v19, v247
    s_waitcnt vmcnt(8)
    s_nop 0
    v_mfma_f32_16x16x32_bf16 v[12:15], v[76:79], v[156:159], v[12:15]
    v_perm_b32 v48, v20, v20, v240
    v_perm_b32 v49, v20, v20, v241
    v_perm_b32 v50, v20, v20, v242
    v_perm_b32 v51, v20, v20, v243
    s_waitcnt vmcnt(8)
    s_nop 0
    v_mfma_f32_16x16x32_bf16 v[12:15], v[48:51], v[160:163], v[12:15]
    v_perm_b32 v52, v20, v20, v244
    v_perm_b32 v53, v20, v20, v245
    v_perm_b32 v54, v20, v20, v246
    v_perm_b32 v55, v20, v20, v247
    s_waitcnt vmcnt(8)
    s_nop 0
    v_mfma_f32_16x16x32_bf16 v[12:15], v[52:55], v[164:167], v[12:15]
    v_perm_b32 v56, v21, v21, v240
    v_perm_b32 v57, v21, v21, v241
    v_perm_b32 v58, v21, v21, v242
    v_perm_b32 v59, v21, v21, v243
    s_waitcnt vmcnt(8)
    s_nop 0
    v_mfma_f32_16x16x32_bf16 v[12:15], v[56:59], v[168:171], v[12:15]
    v_perm_b32 v60, v21, v21, v244
    v_perm_b32 v61, v21, v21, v245
    v_perm_b32 v62, v21, v21, v246
    v_perm_b32 v63, v21, v21, v247
    s_waitcnt vmcnt(8)
    s_nop 0
    v_mfma_f32_16x16x32_bf16 v[12:15], v[60:63], v[172:175], v[12:15]
    v_perm_b32 v64, v22, v22, v240
    v_perm_b32 v65, v22, v22, v241
    v_perm_b32 v66, v22, v22, v242
    v_perm_b32 v67, v22, v22, v243
    s_waitcnt vmcnt(8)
    s_nop 0
    v_mfma_f32_16x16x32_bf16 v[12:15], v[64:67], v[176:179], v[12:15]
    v_perm_b32 v68, v22, v22, v244
    v_perm_b32 v69, v22, v22, v245
    v_perm_b32 v70, v22, v22, v246
    v_perm_b32 v71, v22, v22, v247
    s_waitcnt vmcnt(8)
    s_nop 0
    v_mfma_f32_16x16x32_bf16 v[12:15], v[68:71], v[180:183], v[12:15]
    v_perm_b32 v72, v23, v23, v240
    v_perm_b32 v73, v23, v23, v241
    v_perm_b32 v74, v23, v23, v242
    v_perm_b32 v75, v23, v23, v243
    s_waitcnt vmcnt(8)
    s_nop 0
    v_mfma_f32_16x16x32_bf16 v[12:15], v[72:75], v[184:187], v[12:15]
    v_perm_b32 v76, v23, v23, v244
    v_perm_b32 v77, v23, v23, v245
    v_perm_b32 v78, v23, v23, v246
    v_perm_b32 v79, v23, v23, v247
    s_waitcnt vmcnt(8)
    s_nop 0
    v_mfma_f32_16x16x32_bf16 v[12:15], v[76:79], v[188:191], v[12:15]
    v_perm_b32 v48, v24, v24, v240
    v_perm_b32 v49, v24, v24, v241
    v_perm_b32 v50, v24, v24, v242
    v_perm_b32 v51, v24, v24, v243
    s_waitcnt vmcnt(7)
    s_xor_b32 s62, s43, 196608
    buffer_load_dwordx4 v[96:99], v3, s[44:47], s62 offen
    v_mfma_f32_16x16x32_bf16 v[12:15], v[48:51], v[192:195], v[12:15]
    v_perm_b32 v52, v24, v24, v244
    v_perm_b32 v53, v24, v24, v245
    v_perm_b32 v54, v24, v24, v246
    v_perm_b32 v55, v24, v24, v247
    s_waitcnt vmcnt(7)
    s_xor_b32 s62, s43, 204800
    buffer_load_dwordx4 v[100:103], v3, s[44:47], s62 offen
    v_mfma_f32_16x16x32_bf16 v[12:15], v[52:55], v[196:199], v[12:15]
    v_perm_b32 v56, v25, v25, v240
    v_perm_b32 v57, v25, v25, v241
    v_perm_b32 v58, v25, v25, v242
    v_perm_b32 v59, v25, v25, v243
    s_waitcnt vmcnt(7)
    s_xor_b32 s62, s43, 212992
    buffer_load_dwordx4 v[104:107], v3, s[44:47], s62 offen
    v_mfma_f32_16x16x32_bf16 v[12:15], v[56:59], v[200:203], v[12:15]
    v_perm_b32 v60, v25, v25, v244
    v_perm_b32 v61, v25, v25, v245
    v_perm_b32 v62, v25, v25, v246
    v_perm_b32 v63, v25, v25, v247
    s_waitcnt vmcnt(7)
    s_xor_b32 s62, s43, 221184
    buffer_load_dwordx4 v[108:111], v3, s[44:47], s62 offen
    v_mfma_f32_16x16x32_bf16 v[12:15], v[60:63], v[204:207], v[12:15]
    v_perm_b32 v64, v26, v26, v240
    v_perm_b32 v65, v26, v26, v241
    v_perm_b32 v66, v26, v26, v242
    v_perm_b32 v67, v26, v26, v243
    s_waitcnt vmcnt(7)
    s_xor_b32 s62, s43, 229376
    buffer_load_dwordx4 v[112:115], v3, s[44:47], s62 offen
    v_mfma_f32_16x16x32_bf16 v[12:15], v[64:67], v[208:211], v[12:15]
    v_perm_b32 v68, v26, v26, v244
    v_perm_b32 v69, v26, v26, v245
    v_perm_b32 v70, v26, v26, v246
    v_perm_b32 v71, v26, v26, v247
    s_waitcnt vmcnt(7)
    s_xor_b32 s62, s43, 237568
    buffer_load_dwordx4 v[116:119], v3, s[44:47], s62 offen
    v_mfma_f32_16x16x32_bf16 v[12:15], v[68:71], v[212:215], v[12:15]
    v_perm_b32 v72, v27, v27, v240
    v_perm_b32 v73, v27, v27, v241
    v_perm_b32 v74, v27, v27, v242
    v_perm_b32 v75, v27, v27, v243
    s_waitcnt vmcnt(7)
    s_xor_b32 s62, s43, 245760
    buffer_load_dwordx4 v[120:123], v3, s[44:47], s62 offen
    v_mfma_f32_16x16x32_bf16 v[12:15], v[72:75], v[216:219], v[12:15]
    v_perm_b32 v76, v27, v27, v244
    v_perm_b32 v77, v27, v27, v245
    v_perm_b32 v78, v27, v27, v246
    v_perm_b32 v79, v27, v27, v247
    s_waitcnt vmcnt(7)
    s_xor_b32 s62, s43, 253952
    buffer_load_dwordx4 v[124:127], v3, s[44:47], s62 offen
    v_mfma_f32_16x16x32_bf16 v[12:15], v[76:79], v[220:223], v[12:15]
    v_perm_b32 v48, v28, v28, v240
    v_perm_b32 v49, v28, v28, v241
    v_perm_b32 v50, v28, v28, v242
    v_perm_b32 v51, v28, v28, v243
    s_waitcnt vmcnt(7)
    s_nop 0
    v_mfma_f32_16x16x32_bf16 v[12:15], v[48:51], v[96:99], v[12:15]
    v_perm_b32 v52, v28, v28, v244
    v_perm_b32 v53, v28, v28, v245
    v_perm_b32 v54, v28, v28, v246
    v_perm_b32 v55, v28, v28, v247
    s_waitcnt vmcnt(6)
    s_nop 0
    v_mfma_f32_16x16x32_bf16 v[12:15], v[52:55], v[100:103], v[12:15]
    v_perm_b32 v56, v29, v29, v240
    v_perm_b32 v57, v29, v29, v241
    v_perm_b32 v58, v29, v29, v242
    v_perm_b32 v59, v29, v29, v243
    s_waitcnt vmcnt(5)
    s_nop 0
    v_mfma_f32_16x16x32_bf16 v[12:15], v[56:59], v[104:107], v[12:15]
    v_perm_b32 v60, v29, v29, v244
    v_perm_b32 v61, v29, v29, v245
    v_perm_b32 v62, v29, v29, v246
    v_perm_b32 v63, v29, v29, v247
    s_waitcnt vmcnt(4)
    s_nop 0
    v_mfma_f32_16x16x32_bf16 v[12:15], v[60:63], v[108:111], v[12:15]
    v_perm_b32 v64, v30, v30, v240
    v_perm_b32 v65, v30, v30, v241
    v_perm_b32 v66, v30, v30, v242
    v_perm_b32 v67, v30, v30, v243
    s_waitcnt vmcnt(3)
    s_nop 0
    v_mfma_f32_16x16x32_bf16 v[12:15], v[64:67], v[112:115], v[12:15]
    v_perm_b32 v68, v30, v30, v244
    v_perm_b32 v69, v30, v30, v245
    v_perm_b32 v70, v30, v30, v246
    v_perm_b32 v71, v30, v30, v247
    s_waitcnt vmcnt(2)
    s_nop 0
    v_mfma_f32_16x16x32_bf16 v[12:15], v[68:71], v[116:119], v[12:15]
    v_perm_b32 v72, v31, v31, v240
    v_perm_b32 v73, v31, v31, v241
    v_perm_b32 v74, v31, v31, v242
    v_perm_b32 v75, v31, v31, v243
    s_waitcnt vmcnt(1)
    s_nop 0
    v_mfma_f32_16x16x32_bf16 v[12:15], v[72:75], v[120:123], v[12:15]
    v_perm_b32 v76, v31, v31, v244
    v_perm_b32 v77, v31, v31, v245
    v_perm_b32 v78, v31, v31, v246
    v_perm_b32 v79, v31, v31, v247
    s_waitcnt vmcnt(0)
    s_nop 0
    v_mfma_f32_16x16x32_bf16 v[12:15], v[76:79], v[124:127], v[12:15]
    s_branch L_ctl
L_cons:
    s_waitcnt lgkmcnt(0)
    v_mov_b32 v12, -1
    v_mov_b32 v13, -1
    v_mov_b32 v14, -1
    v_mov_b32 v15, -1
    s_lshl_b32 s61, s2, 10
    v_lshl_add_u32 v8, v0, 4, s61
    s_mov_b32 s61, 21
L_c_rl:
    global_store_dwordx4 v8, v[12:15], s[40:41] sc1
    v_add_u32 v8, 0x2000, v8
    s_sub_u32 s61, s61, 1
    s_cbranch_scc0 L_c_rl
    v_mov_b32 v16, 0
    v_mov_b32 v17, 0
    v_mov_b32 v18, 0
    v_mov_b32 v19, 0
    global_store_dwordx4 v8, v[16:19], s[40:41] sc1
    s_lshl_b32 s61, s2, 2
    v_mov_b32 v9, s61
    v_mov_b32 v10, 1
    s_mov_b64 exec, 1
    s_barrier
    s_waitcnt vmcnt(0)
    global_store_dword v9, v10, s[38:39] sc1
    s_mov_b64 exec, -1
L_c_nc:
    s_cmp_eq_u32 s3, 2
    s_cbranch_scc1 L_padA_0
    s_cmp_eq_u32 s3, 3
    s_cbranch_scc1 L_padB_0
    s_branch L_padC_0
L_pad_back:
    v_and_b32 v8, 1, v0
    v_cmp_eq_u32 vcc, 1, v8
    v_mov_b32 v9, 0x0c0c0100
    v_mov_b32 v10, 0x01000c0c
    v_mov_b32 v11, 0x0c0c0302
    v_mov_b32 v12, 0x03020c0c
    v_mov_b32 v13, 0x0c0c0c0c
    v_bfe_u32 v8, v0, 1, 2
    v_cndmask_b32 v9, v9, v10, vcc
    v_cndmask_b32 v11, v11, v12, vcc
    v_cmp_eq_u32 vcc, 0, v8
    s_nop 1
    v_cndmask_b32 v240, v13, v9, vcc
    v_cndmask_b32 v244, v13, v11, vcc
    v_cmp_eq_u32 vcc, 1, v8
    s_nop 1
    v_cndmask_b32 v241, v13, v9, vcc
    v_cndmask_b32 v245, v13, v11, vcc
    v_cmp_eq_u32 vcc, 2, v8
    s_nop 1
    v_cndmask_b32 v242, v13, v9, vcc
    v_cndmask_b32 v246, v13, v11, vcc
    v_cmp_eq_u32 vcc, 3, v8
    s_nop 1
    v_cndmask_b32 v243, v13, v9, vcc
    v_cndmask_b32 v247, v13, v11, vcc
    v_and_b32 v13, 15, v0
    v_lshrrev_b32 v14, 4, v0
    v_and_b32 v15, 3, v13
    v_lshrrev_b32 v5, 2, v13
    v_lshl_add_u32 v15, v15, 2, v5
    v_xor_b32 v8, v13, v14
    v_lshlrev_b32 v8, 4, v8
    v_lshl_add_u32 v8, v15, 8, v8
    v_xor_b32 v9, 64, v8
    v_xor_b32 v10, 0x80, v8
    v_xor_b32 v11, 0xc0, v8
    v_lshlrev_b32 v12, 4, v0
    v_and_b32 v2, 1, v5
    v_lshl_add_u32 v2, v2, 2, v14
    v_lshlrev_b32 v2, 4, v2
    v_lshrrev_b32 v3, 1, v5
    v_lshl_add_u32 v2, v3, 3, v2
    v_add_u32 v2, v2, v1
    v_lshl_add_u32 v3, v3, 2, v14
    v_lshl_add_u32 v3, v3, 4, v1
    s_sub_u32 s9, s3, 1
    s_mul_i32 s10, s9, 16384
    s_lshl_b32 s11, s9, 2
    v_add_u32 v4, s11, v1
    s_mov_b32 s13, 1035273459
    s_mov_b32 s59, 0
    v_mov_b32 v80, 0
    v_mov_b32 v81, 0
    v_mov_b32 v82, 0
    v_mov_b32 v83, 0
    v_mov_b32 v84, 0
    v_mov_b32 v85, 0
    v_mov_b32 v86, 0
    v_mov_b32 v87, 0
    v_mov_b32 v248, 0
    v_mov_b32 v6, 0
    s_lshl_b32 s15, s9, 2
    s_add_u32 s15, s15, 3
    v_add_u32 v224, s10, v8
    v_add_u32 v225, s10, v9
    v_add_u32 v226, s10, v10
    v_add_u32 v227, s10, v11
    s_lshl_b32 s61, s9, 7
    v_add_u32 v228, s61, v2
    s_add_u32 s9, s9, 3
    v_add_u32 v248, 3, v248
    s_cmp_gt_i32 s59, s15
    s_cbranch_scc1 L_wd_4
    s_mov_b32 s60, 0
L_wl_3:
    ds_read_b32 v230, v1 offset:0
    s_waitcnt lgkmcnt(0)
    v_readfirstlane_b32 s59, v230
    s_cmp_gt_i32 s59, s15
    s_cbranch_scc1 L_wd_4
    s_add_u32 s60, s60, 1
    s_cmp_lt_u32 s60, 1000000
    s_cbranch_scc1 L_wl_3
    s_endpgm
L_padC_0:
    s_branch L_padC_1
L_wd_4:
    ds_read_b128 v[96:99], v224 offset:0
    ds_read_b128 v[100:103], v225 offset:0
    ds_read_b128 v[104:107], v226 offset:0
    ds_read_b128 v[108:111], v227 offset:0
    ds_read_b128 v[112:115], v224 offset:4096
    ds_read_b128 v[116:119], v225 offset:4096
    ds_read_b128 v[120:123], v226 offset:4096
    ds_read_b128 v[124:127], v227 offset:4096
    s_waitcnt lgkmcnt(7)
    ds_read_b128 v[128:131], v224 offset:8192
    s_waitcnt lgkmcnt(7)
    ds_read_b128 v[132:135], v225 offset:8192
    s_waitcnt lgkmcnt(7)
    ds_read_b128 v[136:139], v226 offset:8192
    s_waitcnt lgkmcnt(7)
    ds_read_b128 v[140:143], v227 offset:8192
    s_waitcnt lgkmcnt(7)
    ds_read_b128 v[144:147], v224 offset:12288
    s_waitcnt lgkmcnt(7)
    ds_read_b128 v[148:151], v225 offset:12288
    s_waitcnt lgkmcnt(7)
    ds_read_b128 v[152:155], v226 offset:12288
    s_waitcnt lgkmcnt(7)
    ds_read_b128 v[156:159], v227 offset:12288
    s_waitcnt lgkmcnt(0)
    ds_write_b32 v4, v248 offset:16
    s_add_u32 s10, s10, 49152
    s_cmp_ge_u32 s10, 147456
    s_cselect_b32 s61, 147456, 0
    s_sub_u32 s10, s10, s61
    s_lshl_b32 s15, s9, 2
    s_add_u32 s15, s15, 3
    v_add_u32 v224, s10, v8
    v_add_u32 v225, s10, v9
    v_add_u32 v226, s10, v10
    v_add_u32 v227, s10, v11
    s_lshl_b32 s61, s9, 7
    v_add_u32 v228, s61, v2
    s_add_u32 s9, s9, 3
    v_add_u32 v248, 3, v248
    s_cmp_gt_i32 s59, s15
    s_cbranch_scc1 L_wd_6
    s_mov_b32 s60, 0
L_wl_5:
    ds_read_b32 v230, v1 offset:0
    s_waitcnt lgkmcnt(0)
    v_readfirstlane_b32 s59, v230
    s_cmp_gt_i32 s59, s15
    s_cbranch_scc1 L_wd_6
    s_add_u32 s60, s60, 1
    s_cmp_lt_u32 s60, 1000000
    s_cbranch_scc1 L_wl_5
    s_endpgm
L_padC_1:
    s_branch L_padC_2
L_wd_6:
    ds_read_b128 v[160:163], v224 offset:0
    ds_read_b128 v[164:167], v225 offset:0
    ds_read_b128 v[168:171], v226 offset:0
    ds_read_b128 v[172:175], v227 offset:0
    ds_read_b128 v[176:179], v224 offset:4096
    ds_read_b128 v[180:183], v225 offset:4096
    ds_read_b128 v[184:187], v226 offset:4096
    ds_read_b128 v[188:191], v227 offset:4096
    s_waitcnt lgkmcnt(7)
    ds_read_b128 v[192:195], v224 offset:8192
    s_waitcnt lgkmcnt(7)
    ds_read_b128 v[196:199], v225 offset:8192
    s_waitcnt lgkmcnt(7)
    ds_read_b128 v[200:203], v226 offset:8192
    s_waitcnt lgkmcnt(7)
    ds_read_b128 v[204:207], v227 offset:8192
    s_waitcnt lgkmcnt(7)
    ds_read_b128 v[208:211], v224 offset:12288
    s_waitcnt lgkmcnt(7)
    ds_read_b128 v[212:215], v225 offset:12288
    s_waitcnt lgkmcnt(7)
    ds_read_b128 v[216:219], v226 offset:12288
    s_waitcnt lgkmcnt(7)
    ds_read_b128 v[220:223], v227 offset:12288
    s_waitcnt lgkmcnt(0)
    ds_write_b32 v4, v248 offset:16
    s_add_u32 s10, s10, 49152
    s_cmp_ge_u32 s10, 147456
    s_cselect_b32 s61, 147456, 0
    s_sub_u32 s10, s10, s61
    v_lshl_add_u32 v7, v14, 4, v1
    s_mov_b32 s60, 0
L_w_7:
    ds_read_b32 v16, v1 offset:80
    s_waitcnt lgkmcnt(0)
    v_readfirstlane_b32 s61, v16
    s_cmp_lg_u32 s61, 0
    s_cbranch_scc1 L_d_8
    s_add_u32 s60, s60, 1
    s_cmp_lt_u32 s60, 1000000
    s_cbranch_scc1 L_w_7
    s_endpgm
L_padC_2:
    s_branch L_padC_3
L_d_8:
    ds_read_b128 v[224:227], v7 offset:256
    ds_read_b128 v[228:231], v7 offset:320
    ds_read_b128 v[232:235], v7 offset:384
    ds_read_b128 v[236:239], v7 offset:448
    s_waitcnt lgkmcnt(0)
    v_cmp_eq_u32 vcc, 0, v5
    s_nop 1
    v_cndmask_b32 v16, 0, v224, vcc
    v_cndmask_b32 v17, 0, v225, vcc
    v_cndmask_b32 v18, 0, v226, vcc
    v_cndmask_b32 v19, 0, v227, vcc
    v_cndmask_b32 v20, 0, v228, vcc
    v_cndmask_b32 v21, 0, v229, vcc
    v_cndmask_b32 v22, 0, v230, vcc
    v_cndmask_b32 v23, 0, v231, vcc
    v_cndmask_b32 v24, 0, v232, vcc
    v_cndmask_b32 v25, 0, v233, vcc
    v_cndmask_b32 v26, 0, v234, vcc
    v_cndmask_b32 v27, 0, v235, vcc
    v_cndmask_b32 v28, 0, v236, vcc
    v_cndmask_b32 v29, 0, v237, vcc
    v_cndmask_b32 v30, 0, v238, vcc
    v_cndmask_b32 v31, 0, v239, vcc
    v_cmp_eq_u32 vcc, 1, v5
    s_nop 1
    v_cndmask_b32 v32, 0, v224, vcc
    v_cndmask_b32 v33, 0, v225, vcc
    v_cndmask_b32 v34, 0, v226, vcc
    v_cndmask_b32 v35, 0, v227, vcc
    v_cndmask_b32 v36, 0, v228, vcc
    v_cndmask_b32 v37, 0, v229, vcc
    v_cndmask_b32 v38, 0, v230, vcc
    v_cndmask_b32 v39, 0, v231, vcc
    v_cndmask_b32 v40, 0, v232, vcc
    v_cndmask_b32 v41, 0, v233, vcc
    v_cndmask_b32 v42, 0, v234, vcc
    v_cndmask_b32 v43, 0, v235, vcc
    v_cndmask_b32 v44, 0, v236, vcc
    v_cndmask_b32 v45, 0, v237, vcc
    v_cndmask_b32 v46, 0, v238, vcc
    v_cndmask_b32 v47, 0, v239, vcc
    v_cmp_eq_u32 vcc, 2, v5
    s_nop 1
    v_cndmask_b32 v48, 0, v224, vcc
    v_cndmask_b32 v49, 0, v225, vcc
    v_cndmask_b32 v50, 0, v226, vcc
    v_cndmask_b32 v51, 0, v227, vcc
    v_cndmask_b32 v52, 0, v228, vcc
    v_cndmask_b32 v53, 0, v229, vcc
    v_cndmask_b32 v54, 0, v230, vcc
    v_cndmask_b32 v55, 0, v231, vcc
    v_cndmask_b32 v56, 0, v232, vcc
    v_cndmask_b32 v57, 0, v233, vcc
    v_cndmask_b32 v58, 0, v234, vcc
    v_cndmask_b32 v59, 0, v235, vcc
    v_cndmask_b32 v60, 0, v236, vcc
    v_cndmask_b32 v61, 0, v237, vcc
    v_cndmask_b32 v62, 0, v238, vcc
    v_cndmask_b32 v63, 0, v239, vcc
    v_cmp_eq_u32 vcc, 3, v5
    s_nop 1
    v_cndmask_b32 v64, 0, v224, vcc
    v_cndmask_b32 v65, 0, v225, vcc
    v_cndmask_b32 v66, 0, v226, vcc
    v_cndmask_b32 v67, 0, v227, vcc
    v_cndmask_b32 v68, 0, v228, vcc
    v_cndmask_b32 v69, 0, v229, vcc
    v_cndmask_b32 v70, 0, v230, vcc
    v_cndmask_b32 v71, 0, v231, vcc
    v_cndmask_b32 v72, 0, v232, vcc
    v_cndmask_b32 v73, 0, v233, vcc
    v_cndmask_b32 v74, 0, v234, vcc
    v_cndmask_b32 v75, 0, v235, vcc
    v_cndmask_b32 v76, 0, v236, vcc
    v_cndmask_b32 v77, 0, v237, vcc
    v_cndmask_b32 v78, 0, v238, vcc
    v_cndmask_b32 v79, 0, v239, vcc
    s_sub_u32 s61, s9, 6
    s_lshl_b32 s61, s61, 7
    v_add_u32 v15, s61, v2
    v_mfma_f32_16x16x32_bf16 v[88:91], v[96:99], v[16:19], 0
    v_mfma_f32_16x16x32_bf16 v[88:91], v[100:103], v[20:23], v[88:91]
    v_mfma_f32_16x16x32_bf16 v[88:91], v[104:107], v[24:27], v[88:91]
    v_mfma_f32_16x16x32_bf16 v[88:91], v[108:111], v[28:31], v[88:91]
    v_mfma_f32_16x16x32_bf16 v[88:91], v[112:115], v[32:35], v[88:91]
    v_mfma_f32_16x16x32_bf16 v[88:91], v[116:119], v[36:39], v[88:91]
    v_mfma_f32_16x16x32_bf16 v[88:91], v[120:123], v[40:43], v[88:91]
    v_mfma_f32_16x16x32_bf16 v[88:91], v[124:127], v[44:47], v[88:91]
    v_mfma_f32_16x16x32_bf16 v[88:91], v[128:131], v[48:51], v[88:91]
    v_mfma_f32_16x16x32_bf16 v[88:91], v[132:135], v[52:55], v[88:91]
    v_mfma_f32_16x16x32_bf16 v[88:91], v[136:139], v[56:59], v[88:91]
    v_mfma_f32_16x16x32_bf16 v[88:91], v[140:143], v[60:63], v[88:91]
    v_mfma_f32_16x16x32_bf16 v[88:91], v[144:147], v[64:67], v[88:91]
    v_mfma_f32_16x16x32_bf16 v[88:91], v[148:151], v[68:71], v[88:91]
    v_mfma_f32_16x16x32_bf16 v[88:91], v[152:155], v[72:75], v[88:91]
    v_mfma_f32_16x16x32_bf16 v[88:91], v[156:159], v[76:79], v[88:91]
    s_nop 7
    v_cvt_pk_bf16_f32 v230, v88, v89
    v_cvt_pk_bf16_f32 v231, v90, v91
    v_lshlrev_b32 v88, 16, v230
    v_and_b32 v89, 0xffff0000, v230
    v_lshlrev_b32 v90, 16, v231
    v_and_b32 v91, 0xffff0000, v231
    v_mul_f32 v88, s13, v88
    v_mul_f32 v89, s13, v89
    v_mul_f32 v90, s13, v90
    v_mul_f32 v91, s13, v91
    v_cvt_pk_bf16_f32 v230, v88, v89
    v_cvt_pk_bf16_f32 v231, v90, v91
    ds_write_b64 v15, v[230:231] offset:1024
L_k_loop:
    s_lshl_b32 s15, s9, 2
    s_add_u32 s15, s15, 3
    v_add_u32 v224, s10, v8
    v_add_u32 v225, s10, v9
    v_add_u32 v226, s10, v10
    v_add_u32 v227, s10, v11
    s_lshl_b32 s61, s9, 7
    v_add_u32 v228, s61, v2
    s_add_u32 s9, s9, 3
    v_add_u32 v248, 3, v248
    s_cmp_gt_i32 s59, s15
    s_cbranch_scc1 L_wd_10
    s_mov_b32 s60, 0
L_wl_9:
    ds_read_b32 v230, v1 offset:0
    s_waitcnt lgkmcnt(0)
    v_readfirstlane_b32 s59, v230
    s_cmp_gt_i32 s59, s15
    s_cbranch_scc1 L_wd_10
    s_add_u32 s60, s60, 1
    s_cmp_lt_u32 s60, 1000000
    s_cbranch_scc1 L_wl_9
    s_endpgm
L_padC_3:
    s_branch L_padC_4
L_wd_10:
    ds_read_b128 v[96:99], v224 offset:0
    ds_read_b128 v[100:103], v225 offset:0
    ds_read_b128 v[104:107], v226 offset:0
    ds_read_b128 v[108:111], v227 offset:0
    ds_read_b128 v[112:115], v224 offset:4096
    ds_read_b128 v[116:119], v225 offset:4096
    ds_read_b128 v[120:123], v226 offset:4096
    ds_read_b128 v[124:127], v227 offset:4096
    s_waitcnt lgkmcnt(7)
    v_mfma_f32_16x16x32_bf16 v[88:91], v[96:99], v[16:19], 0
    ds_read_b128 v[128:131], v224 offset:8192
    s_waitcnt lgkmcnt(7)
    v_mfma_f32_16x16x32_bf16 v[88:91], v[100:103], v[20:23], v[88:91]
    ds_read_b128 v[132:135], v225 offset:8192
    s_waitcnt lgkmcnt(7)
    v_mfma_f32_16x16x32_bf16 v[88:91], v[104:107], v[24:27], v[88:91]
    ds_read_b128 v[136:139], v226 offset:8192
    s_waitcnt lgkmcnt(7)
    v_mfma_f32_16x16x32_bf16 v[88:91], v[108:111], v[28:31], v[88:91]
    ds_read_b128 v[140:143], v227 offset:8192
    s_waitcnt lgkmcnt(7)
    v_mfma_f32_16x16x32_bf16 v[88:91], v[112:115], v[32:35], v[88:91]
    ds_read_b128 v[144:147], v224 offset:12288
    s_waitcnt lgkmcnt(7)
    v_mfma_f32_16x16x32_bf16 v[88:91], v[116:119], v[36:39], v[88:91]
    ds_read_b128 v[148:151], v225 offset:12288
    s_waitcnt lgkmcnt(7)
    v_mfma_f32_16x16x32_bf16 v[88:91], v[120:123], v[40:43], v[88:91]
    ds_read_b128 v[152:155], v226 offset:12288
    s_waitcnt lgkmcnt(7)
    v_mfma_f32_16x16x32_bf16 v[88:91], v[124:127], v[44:47], v[88:91]
    ds_read_b128 v[156:159], v227 offset:12288
    s_waitcnt lgkmcnt(7)
    v_mfma_f32_16x16x32_bf16 v[88:91], v[128:131], v[48:51], v[88:91]
    s_waitcnt lgkmcnt(6)
    v_mfma_f32_16x16x32_bf16 v[88:91], v[132:135], v[52:55], v[88:91]
    s_waitcnt lgkmcnt(5)
    v_mfma_f32_16x16x32_bf16 v[88:91], v[136:139], v[56:59], v[88:91]
    s_waitcnt lgkmcnt(4)
    v_mfma_f32_16x16x32_bf16 v[88:91], v[140:143], v[60:63], v[88:91]
    s_waitcnt lgkmcnt(3)
    v_mfma_f32_16x16x32_bf16 v[88:91], v[144:147], v[64:67], v[88:91]
    s_waitcnt lgkmcnt(2)
    v_mfma_f32_16x16x32_bf16 v[88:91], v[148:151], v[68:71], v[88:91]
    s_waitcnt lgkmcnt(1)
    v_mfma_f32_16x16x32_bf16 v[88:91], v[152:155], v[72:75], v[88:91]
    s_waitcnt lgkmcnt(0)
    ds_write_b32 v4, v248 offset:16
    v_mfma_f32_16x16x32_bf16 v[88:91], v[156:159], v[76:79], v[88:91]
    s_add_u32 s10, s10, 49152
    s_cmp_ge_u32 s10, 147456
    s_cselect_b32 s61, 147456, 0
    s_sub_u32 s10, s10, s61
    s_nop 3
    v_cvt_pk_bf16_f32 v230, v88, v89
    v_cvt_pk_bf16_f32 v231, v90, v91
    v_lshlrev_b32 v88, 16, v230
    v_and_b32 v89, 0xffff0000, v230
    v_lshlrev_b32 v90, 16, v231
    v_and_b32 v91, 0xffff0000, v231
    v_mul_f32 v88, s13, v88
    v_mul_f32 v89, s13, v89
    v_mul_f32 v90, s13, v90
    v_mul_f32 v91, s13, v91
    v_cvt_pk_bf16_f32 v230, v88, v89
    v_cvt_pk_bf16_f32 v231, v90, v91
    s_sub_u32 s61, s9, 30
    s_cmp_lt_u32 s61, 3
    ds_write_b64 v228, v[230:231] offset:1024
    s_cbranch_scc0 L_k_nb
    v_mfma_f32_16x16x32_bf16 v[88:91], v[160:163], v[16:19], 0
    v_mfma_f32_16x16x32_bf16 v[88:91], v[164:167], v[20:23], v[88:91]
    v_mfma_f32_16x16x32_bf16 v[88:91], v[168:171], v[24:27], v[88:91]
    v_mfma_f32_16x16x32_bf16 v[88:91], v[172:175], v[28:31], v[88:91]
    v_mfma_f32_16x16x32_bf16 v[88:91], v[176:179], v[32:35], v[88:91]
    v_mfma_f32_16x16x32_bf16 v[88:91], v[180:183], v[36:39], v[88:91]
    v_mfma_f32_16x16x32_bf16 v[88:91], v[184:187], v[40:43], v[88:91]
    v_mfma_f32_16x16x32_bf16 v[88:91], v[188:191], v[44:47], v[88:91]
    v_mfma_f32_16x16x32_bf16 v[88:91], v[192:195], v[48:51], v[88:91]
    v_mfma_f32_16x16x32_bf16 v[88:91], v[196:199], v[52:55], v[88:91]
    v_mfma_f32_16x16x32_bf16 v[88:91], v[200:203], v[56:59], v[88:91]
    v_mfma_f32_16x16x32_bf16 v[88:91], v[204:207], v[60:63], v[88:91]
    v_mfma_f32_16x16x32_bf16 v[88:91], v[208:211], v[64:67], v[88:91]
    v_mfma_f32_16x16x32_bf16 v[88:91], v[212:215], v[68:71], v[88:91]
    v_mfma_f32_16x16x32_bf16 v[88:91], v[216:219], v[72:75], v[88:91]
    v_mfma_f32_16x16x32_bf16 v[88:91], v[220:223], v[76:79], v[88:91]
    s_nop 7
    v_cvt_pk_bf16_f32 v230, v88, v89
    v_cvt_pk_bf16_f32 v231, v90, v91
    v_lshlrev_b32 v88, 16, v230
    v_and_b32 v89, 0xffff0000, v230
    v_lshlrev_b32 v90, 16, v231
    v_and_b32 v91, 0xffff0000, v231
    v_mul_f32 v88, s13, v88
    v_mul_f32 v89, s13, v89
    v_mul_f32 v90, s13, v90
    v_mul_f32 v91, s13, v91
    v_cvt_pk_bf16_f32 v230, v88, v89
    v_cvt_pk_bf16_f32 v231, v90, v91
    ds_write_b64 v15, v[230:231] offset:1408
    s_cmp_eq_u32 s3, 2
    s_cbranch_scc1 L_padD_0
    s_cmp_eq_u32 s3, 3
    s_cbranch_scc1 L_padE_0
    s_cbranch_scc0 L_padF_0
L_k_nb:
    s_cmp_lt_u32 s9, 64
    s_cbranch_scc1 L_k_loop
    v_mov_b32 v197, 1
    ds_write_b32 v4, v197 offset:64
    s_lshl_b32 s61, s4, 11
    s_lshl_b32 s62, s5, 8
    s_add_u32 s62, s62, s61
    v_lshlrev_b32 v13, 4, v13
    v_lshl_add_u32 v13, v14, 3, v13
    v_add_u32 v13, s62, v13
    v_and_b32 v10, 7, v0
    v_lshlrev_b32 v11, 8, v10
    v_lshl_add_u32 v11, v14, 4, v11
    v_and_b32 v10, 8, v0
    v_lshl_add_u32 v11, v10, 3, v11
    v_add_u32 v11, s61, v11
    v_and_b32 v10, 3, v0
    v_lshl_add_u32 v9, v14, 3, v5
    v_lshlrev_b32 v9, 7, v9
    v_lshl_add_u32 v9, v10, 3, v9
    s_lshl_b32 s61, s3, 6
    s_add_u32 s61, s61, 32704
    v_add_u32 v9, s61, v9
    v_and_b32 v8, 15, v0
    v_lshrrev_b32 v7, 1, v14
    v_lshl_add_u32 v8, v7, 4, v8
    s_sub_u32 s62, s3, 1
    s_and_b32 s62, s62, 1
    s_lshl_b32 s61, s62, 7
    v_lshl_add_u32 v7, v8, 2, s61
    v_add_u32 v7, v7, v1
    s_lshl_b32 s61, s5, 1
    s_add_u32 s61, s61, s62
    s_lshl_b32 s62, s61, 6
    v_lshl_add_u32 v6, v8, 1, s62
    s_lshl_b32 s61, s61, 9
    s_add_u32 s61, s61, 180224
    v_and_b32 v8, 15, v0
    v_lshlrev_b32 v8, 2, v8
    v_lshl_add_u32 v60, v14, 7, v8
    v_add_u32 v60, s61, v60
    s_mov_b32 s44, 0xaaaa5555
    s_mov_b32 s45, s44
    s_mov_b32 s60, 0
L_w_11:
    ds_read_b32 v198, v1 offset:36
    s_waitcnt lgkmcnt(0)
    v_readfirstlane_b32 s61, v198
    s_cmp_lg_u32 s61, 0
    s_cbranch_scc1 L_d_12
    s_add_u32 s60, s60, 1
    s_cmp_lt_u32 s60, 1000000
    s_cbranch_scc1 L_w_11
    s_endpgm
L_padD_0:
    s_branch L_padD_1
L_d_12:
L_v_loop:
    s_sub_u32 s61, s9, 64
    s_lshl_b32 s61, s61, 7
    v_add_u32 v196, s61, v3
    ds_read_b128 v[88:91], v196 offset:1024
    v_add_u32 v192, s10, v12
    s_lshl_b32 s15, s9, 2
    s_add_u32 s9, s9, 3
    v_add_u32 v248, 3, v248
    s_waitcnt lgkmcnt(0)
    v_perm_b32 v160, v88, v88, v240
    v_perm_b32 v161, v88, v88, v241
    v_perm_b32 v162, v88, v88, v242
    v_perm_b32 v163, v88, v88, v243
    v_perm_b32 v164, v88, v88, v244
    v_perm_b32 v165, v88, v88, v245
    v_perm_b32 v166, v88, v88, v246
    v_perm_b32 v167, v88, v88, v247
    v_perm_b32 v168, v89, v89, v240
    v_perm_b32 v169, v89, v89, v241
    v_perm_b32 v170, v89, v89, v242
    v_perm_b32 v171, v89, v89, v243
    v_perm_b32 v172, v89, v89, v244
    v_perm_b32 v173, v89, v89, v245
    v_perm_b32 v174, v89, v89, v246
    v_perm_b32 v175, v89, v89, v247
    v_perm_b32 v176, v90, v90, v240
    v_perm_b32 v177, v90, v90, v241
    v_perm_b32 v178, v90, v90, v242
    v_perm_b32 v179, v90, v90, v243
    v_perm_b32 v180, v90, v90, v244
    v_perm_b32 v181, v90, v90, v245
    v_perm_b32 v182, v90, v90, v246
    v_perm_b32 v183, v90, v90, v247
    v_perm_b32 v184, v91, v91, v240
    v_perm_b32 v185, v91, v91, v241
    v_perm_b32 v186, v91, v91, v242
    v_perm_b32 v187, v91, v91, v243
    v_perm_b32 v188, v91, v91, v244
    v_perm_b32 v189, v91, v91, v245
    v_perm_b32 v190, v91, v91, v246
    v_perm_b32 v191, v91, v91, v247
    s_cmp_eq_u32 s9, 130
    s_cbranch_scc1 L_v_merge
L_v_w0:
    s_add_u32 s15, s15, 1
    s_cmp_gt_i32 s59, s15
    s_cbranch_scc1 L_wd_14
    s_mov_b32 s60, 0
L_wl_13:
    ds_read_b32 v198, v1 offset:0
    s_waitcnt lgkmcnt(0)
    v_readfirstlane_b32 s59, v198
    s_cmp_gt_i32 s59, s15
    s_cbranch_scc1 L_wd_14
    s_add_u32 s60, s60, 1
    s_cmp_lt_u32 s60, 1000000
    s_cbranch_scc1 L_wl_13
    s_endpgm
L_padD_1:
    s_branch L_padD_2
L_wd_14:
    ds_read_b128 v[96:99], v192 offset:0
    ds_read_b128 v[100:103], v192 offset:4096
    ds_read_b128 v[104:107], v192 offset:1024
    ds_read_b128 v[108:111], v192 offset:5120
    ds_read_b128 v[112:115], v192 offset:2048
    ds_read_b128 v[116:119], v192 offset:6144
    ds_read_b128 v[120:123], v192 offset:3072
    ds_read_b128 v[124:127], v192 offset:7168
    s_waitcnt lgkmcnt(7)
    v_mfma_f32_16x16x32_bf16 v[80:83], v[160:163], v[96:99], v[80:83]
    s_waitcnt lgkmcnt(6)
    v_mfma_f32_16x16x32_bf16 v[84:87], v[160:163], v[100:103], v[84:87]
    s_waitcnt lgkmcnt(5)
    v_mfma_f32_16x16x32_bf16 v[80:83], v[164:167], v[104:107], v[80:83]
    s_waitcnt lgkmcnt(4)
    v_mfma_f32_16x16x32_bf16 v[84:87], v[164:167], v[108:111], v[84:87]
    s_waitcnt lgkmcnt(3)
    v_mfma_f32_16x16x32_bf16 v[80:83], v[168:171], v[112:115], v[80:83]
    s_waitcnt lgkmcnt(2)
    v_mfma_f32_16x16x32_bf16 v[84:87], v[168:171], v[116:119], v[84:87]
    s_waitcnt lgkmcnt(1)
    v_mfma_f32_16x16x32_bf16 v[80:83], v[172:175], v[120:123], v[80:83]
    s_waitcnt lgkmcnt(0)
    v_mfma_f32_16x16x32_bf16 v[84:87], v[172:175], v[124:127], v[84:87]
    s_add_u32 s15, s15, 2
    s_cmp_gt_i32 s59, s15
    s_cbranch_scc1 L_wd_16
    s_mov_b32 s60, 0
L_wl_15:
    ds_read_b32 v198, v1 offset:0
    s_waitcnt lgkmcnt(0)
    v_readfirstlane_b32 s59, v198
    s_cmp_gt_i32 s59, s15
    s_cbranch_scc1 L_wd_16
    s_add_u32 s60, s60, 1
    s_cmp_lt_u32 s60, 1000000
    s_cbranch_scc1 L_wl_15
    s_endpgm
L_padD_2:
    s_branch L_padD_3
L_wd_16:
    ds_read_b128 v[128:131], v192 offset:8192
    ds_read_b128 v[132:135], v192 offset:12288
    ds_read_b128 v[136:139], v192 offset:9216
    ds_read_b128 v[140:143], v192 offset:13312
    ds_read_b128 v[144:147], v192 offset:10240
    ds_read_b128 v[148:151], v192 offset:14336
    ds_read_b128 v[152:155], v192 offset:11264
    ds_read_b128 v[156:159], v192 offset:15360
    s_waitcnt lgkmcnt(7)
    v_mfma_f32_16x16x32_bf16 v[80:83], v[176:179], v[128:131], v[80:83]
    s_waitcnt lgkmcnt(6)
    v_mfma_f32_16x16x32_bf16 v[84:87], v[176:179], v[132:135], v[84:87]
    s_waitcnt lgkmcnt(5)
    v_mfma_f32_16x16x32_bf16 v[80:83], v[180:183], v[136:139], v[80:83]
    s_waitcnt lgkmcnt(4)
    v_mfma_f32_16x16x32_bf16 v[84:87], v[180:183], v[140:143], v[84:87]
    s_waitcnt lgkmcnt(3)
    v_mfma_f32_16x16x32_bf16 v[80:83], v[184:187], v[144:147], v[80:83]
    s_waitcnt lgkmcnt(2)
    v_mfma_f32_16x16x32_bf16 v[84:87], v[184:187], v[148:151], v[84:87]
    s_waitcnt lgkmcnt(1)
    v_mfma_f32_16x16x32_bf16 v[80:83], v[188:191], v[152:155], v[80:83]
    s_waitcnt lgkmcnt(0)
    ds_write_b32 v4, v248 offset:16
    v_mfma_f32_16x16x32_bf16 v[84:87], v[188:191], v[156:159], v[84:87]
    s_add_u32 s10, s10, 49152
    s_cmp_ge_u32 s10, 147456
    s_cselect_b32 s61, 147456, 0
    s_sub_u32 s10, s10, s61
    s_cmp_lt_u32 s9, 128
    s_cbranch_scc1 L_v_loop
    s_cmp_eq_u32 s9, 130
    s_nop 0
    v_permlane32_swap_b32 v84, v88
    v_permlane32_swap_b32 v85, v89
    v_permlane32_swap_b32 v86, v90
    v_permlane32_swap_b32 v87, v91
    s_nop 1
    v_add_f32 v80, v80, v88
    v_add_f32 v81, v81, v89
    v_add_f32 v82, v82, v90
    v_add_f32 v83, v83, v91
    s_mov_b32 exec_hi, 0
    s_cbranch_scc0 L_c_other
    v_mul_f32 v80, v80, v212
    v_mul_f32 v81, v81, v212
    v_mul_f32 v82, v82, v212
    v_mul_f32 v83, v83, v212
    v_cvt_pk_bf16_f32 v80, v80, v81
    v_cvt_pk_bf16_f32 v81, v82, v83
    v_min_u32 v80, -2, v80
    v_min_u32 v81, -2, v81
    global_store_dwordx2 v13, v[80:81], s[40:41] sc1
    ds_write_b32 v1, v248 offset:96
    s_mov_b32 exec_hi, -1
    s_branch L_hop1
L_padD_3:
    s_branch L_padD_4
L_v_merge:
    v_and_b32 v200, 0x1ff, v12
    v_add_u32 v200, v200, v1
    s_mov_b32 s60, 0
L_w_17:
    ds_read_b32 v204, v1 offset:40
    s_waitcnt lgkmcnt(0)
    v_readfirstlane_b32 s61, v204
    s_cmp_lg_u32 s61, 0
    s_cbranch_scc1 L_d_18
    s_add_u32 s60, s60, 1
    s_cmp_lt_u32 s60, 1000000
    s_cbranch_scc1 L_w_17
    s_endpgm
L_padD_4:
    s_branch L_padD_5
L_d_18:
    s_mov_b32 s60, 0
L_w_19:
    ds_read_b96 v[204:206], v1 offset:48
    s_waitcnt lgkmcnt(0)
    v_add3_u32 v204, v204, v205, v206
    s_nop 0
    v_readfirstlane_b32 s61, v204
    s_cmp_eq_u32 s61, 2
    s_cbranch_scc1 L_d_20
    s_add_u32 s60, s60, 1
    s_cmp_lt_u32 s60, 1000000
    s_cbranch_scc1 L_w_19
    s_endpgm
L_padD_5:
    s_branch L_padD_6
L_d_20:
    ds_read_b128 v[204:207], v200 offset:1024
    ds_read_b128 v[208:211], v200 offset:2048
    ds_read_b32 v212, v1 offset:44
    s_waitcnt lgkmcnt(0)
    v_add_f32 v204, v204, v208
    v_add_f32 v205, v205, v209
    v_add_f32 v206, v206, v210
    v_add_f32 v207, v207, v211
    v_add_f32 v80, v80, v204
    v_add_f32 v81, v81, v205
    v_add_f32 v82, v82, v206
    v_add_f32 v83, v83, v207
    s_branch L_v_w0
L_padD_6:
    s_branch L_padD_7
L_c_other:
    s_sub_u32 s61, s3, 1
    s_mul_i32 s61, s61, 512
    v_add3_u32 v196, s61, v1, v12
    v_mov_b32 v197, 1
    ds_write_b128 v196, v[80:83] offset:1024
    ds_write_b32 v4, v197 offset:48
    s_mov_b32 exec_hi, -1
    s_cmp_eq_u32 s3, 1
    s_cbranch_scc0 L_end
    s_mov_b32 s60, 0
L_w_21:
    ds_read_b32 v198, v1 offset:96
    s_waitcnt lgkmcnt(0)
    v_readfirstlane_b32 s61, v198
    s_cmp_lg_u32 s61, 0
    s_cbranch_scc1 L_d_22
    s_add_u32 s60, s60, 1
    s_cmp_lt_u32 s60, 1000000
    s_cbranch_scc1 L_w_21
    s_endpgm
L_padD_7:
    s_branch L_padD_8
L_d_22:
L_hop1:
    global_load_dwordx4 v[16:19], v11, s[40:41] sc1
    global_load_dwordx4 v[20:23], v11, s[40:41] offset:128 sc1
    s_mov_b32 s15, 513
    s_cmp_gt_i32 s59, s15
    s_cbranch_scc1 L_wd_24
    s_mov_b32 s60, 0
L_wl_23:
    ds_read_b32 v198, v1 offset:0
    s_waitcnt lgkmcnt(0)
    v_readfirstlane_b32 s59, v198
    s_cmp_gt_i32 s59, s15
    s_cbranch_scc1 L_wd_24
    s_add_u32 s60, s60, 1
    s_cmp_lt_u32 s60, 1000000
    s_cbranch_scc1 L_wl_23
    s_endpgm
L_padD_8:
    s_branch L_padD_9
L_wd_24:
    ds_read_b64_tr_b16 v[96:97], v9 offset:0
    ds_read_b64_tr_b16 v[98:99], v9 offset:512
    ds_read_b64_tr_b16 v[112:113], v9 offset:32
    ds_read_b64_tr_b16 v[114:115], v9 offset:544
    ds_read_b64_tr_b16 v[100:101], v9 offset:4096
    ds_read_b64_tr_b16 v[102:103], v9 offset:4608
    ds_read_b64_tr_b16 v[116:117], v9 offset:4128
    ds_read_b64_tr_b16 v[118:119], v9 offset:4640
    s_mov_b32 s15, 515
    s_cmp_gt_i32 s59, s15
    s_cbranch_scc1 L_wd_26
    s_mov_b32 s60, 0
L_wl_25:
    ds_read_b32 v198, v1 offset:0
    s_waitcnt lgkmcnt(0)
    v_readfirstlane_b32 s59, v198
    s_cmp_gt_i32 s59, s15
    s_cbranch_scc1 L_wd_26
    s_add_u32 s60, s60, 1
    s_cmp_lt_u32 s60, 1000000
    s_cbranch_scc1 L_wl_25
    s_endpgm
L_padD_9:
    s_branch L_padD_10
L_wd_26:
    ds_read_b64_tr_b16 v[104:105], v9 offset:8192
    ds_read_b64_tr_b16 v[106:107], v9 offset:8704
    ds_read_b64_tr_b16 v[120:121], v9 offset:8224
    ds_read_b64_tr_b16 v[122:123], v9 offset:8736
    ds_read_b64_tr_b16 v[108:109], v9 offset:12288
    ds_read_b64_tr_b16 v[110:111], v9 offset:12800
    ds_read_b64_tr_b16 v[124:125], v9 offset:12320
    ds_read_b64_tr_b16 v[126:127], v9 offset:12832
    s_mov_b32 s60, 0
L_h_poll:
    s_waitcnt vmcnt(0)
    v_max3_u32 v58, v16, v17, v18
    v_max3_u32 v58, v58, v19, v20
    v_max3_u32 v58, v58, v21, v22
    v_max_u32 v58, v58, v23
    v_cmp_eq_u32 vcc, -1, v58
    s_cbranch_vccz L_h_ok0
    global_load_dwordx4 v[16:19], v11, s[40:41] sc1
    global_load_dwordx4 v[20:23], v11, s[40:41] offset:128 sc1
    s_add_u32 s60, s60, 1
    s_cmp_lt_u32 s60, 1000000
    s_cbranch_scc1 L_h_poll
    s_endpgm
L_padD_10:
    s_branch L_padD_11
L_h_ok0:
    s_waitcnt lgkmcnt(0)
    v_mfma_f32_16x16x32_bf16 v[40:43], v[16:19], v[96:99], 0
    v_mfma_f32_16x16x32_bf16 v[44:47], v[16:19], v[100:103], 0
    v_mfma_f32_16x16x32_bf16 v[48:51], v[16:19], v[112:115], 0
    v_mfma_f32_16x16x32_bf16 v[52:55], v[16:19], v[116:119], 0
    v_mfma_f32_16x16x32_bf16 v[40:43], v[20:23], v[104:107], v[40:43]
    v_mfma_f32_16x16x32_bf16 v[44:47], v[20:23], v[108:111], v[44:47]
    v_mfma_f32_16x16x32_bf16 v[48:51], v[20:23], v[120:123], v[48:51]
    v_mfma_f32_16x16x32_bf16 v[52:55], v[20:23], v[124:127], v[52:55]
L_h_red:
    s_mov_b32 vcc_lo, -1
    s_mov_b32 vcc_hi, 0
    s_nop 1
    ds_read_b32 v66, v7 offset:640
    v_add_f32 v40, v40, v41
    v_add_f32 v42, v42, v43
    v_add_f32 v44, v44, v45
    v_add_f32 v46, v46, v47
    v_add_f32 v48, v48, v49
    v_add_f32 v50, v50, v51
    v_add_f32 v52, v52, v53
    v_add_f32 v54, v54, v55
    v_cndmask_b32 v40, v44, v40, vcc
    v_cndmask_b32 v42, v46, v42, vcc
    v_cndmask_b32 v48, v52, v48, vcc
    v_cndmask_b32 v50, v54, v50, vcc
    v_add_f32 v40, v40, v42
    v_add_f32 v48, v48, v50
    s_nop 1
    v_permlane32_swap_b32 v40, v48
    s_nop 0
    v_add_f32 v56, v40, v48
    v_add_f32 v58, v40, v48
    s_waitcnt lgkmcnt(0)
    v_cmp_eq_u32 vcc, -1, v66
    v_permlane16_swap_b32 v56, v58
    s_cbranch_vccnz L_h_bw
L_h_bok:
    v_add_f32 v56, v56, v58
    v_add_f32 v56, v56, v66
    v_cndmask_b32 v56, 1.0, v56, s[44:45]
    global_atomic_add_f32 v66, v60, v56, s[40:41] sc0 sc1
    s_waitcnt vmcnt(0)
    v_mov_b32_dpp v58, v66 quad_perm:[1,0,3,2] row_mask:0xf bank_mask:0xf
    v_add_f32 v56, v56, v66
    v_cmp_eq_f32 vcc, 0x41f80000, v58
    v_cvt_pk_bf16_f32 v56, v56, v56
    s_and_b64 exec, vcc, s[44:45]
    s_cbranch_execz L_o_n
    global_store_short v6, v56, s[36:37]
L_o_n:
    s_endpgm
L_padD_11:
    s_branch L_k_nb
L_h_bw:
    s_mov_b32 s60, 0
L_h_bl:
    ds_read_b32 v66, v7 offset:640
    s_waitcnt lgkmcnt(0)
    v_cmp_eq_u32 vcc, -1, v66
    s_cbranch_vccz L_h_bok
    s_add_u32 s60, s60, 1
    s_cmp_lt_u32 s60, 1000000
    s_cbranch_scc1 L_h_bl
    s_endpgm
L_padA_0:
    s_branch L_padA_1
L_ctl:
    s_mov_b32 s48, -15
    s_mov_b32 s49, 3
    s_mov_b32 s50, 74
    s_lshl_b32 s62, s4, 11
    s_add_u32 s62, s62, 65536
    v_lshl_add_u32 v6, v0, 4, s62
    s_lshl_b32 s61, s6, 9
    s_add_u32 s62, s62, s61
    v_and_b32 v10, 15, v0
    v_and_b32 v11, 16, v0
    v_lshl_add_u32 v7, v10, 5, v11
    v_add_u32 v7, s62, v7
    s_mul_i32 s61, s7, 8
    s_lshl_b32 s8, 0xff00ff, s61
    v_min_u32 v12, -2, v12
    v_min_u32 v13, -2, v13
    v_min_u32 v14, -2, v14
    v_min_u32 v15, -2, v15
    s_mov_b32 s60, 0
L_w_27:
    ds_read_b32 v8, v1 offset:0
    s_waitcnt lgkmcnt(0)
    v_readfirstlane_b32 s61, v8
    s_cmp_ge_i32 s61, 17
    s_cbranch_scc1 L_d_28
    s_sleep 1
    s_add_u32 s60, s60, 1
    s_cmp_lt_u32 s60, 1000000
    s_cbranch_scc1 L_w_27
    s_endpgm
L_padA_1:
    s_branch L_padA_2
L_d_28:
    v_and_b32 v8, 7, v0
    v_lshlrev_b32 v9, 2, v8
    v_mul_u32_u24 v3, 128, v8
    v_add_u32 v3, 163840, v3
    s_and_b32 s61, s2, 7
    s_mul_i32 s61, s61, 128
    s_add_u32 s61, s61, 163840
    v_lshl_add_u32 v2, v0, 2, s61
    s_mov_b32 s60, 0
L_fl_29:
    global_load_dword v10, v9, s[38:39] sc1
    s_waitcnt vmcnt(0)
    v_cmp_eq_u32 vcc, 0, v10
    s_cbranch_vccz L_fld_30
    s_sleep 16
    s_add_u32 s60, s60, 1
    s_cmp_lt_u32 s60, 1000000
    s_cbranch_scc1 L_fl_29
    s_endpgm
L_padA_2:
    s_branch L_padA_3
L_fld_30:
    s_mov_b32 exec_lo, s8
    s_mov_b32 exec_hi, 0
    global_store_dwordx4 v7, v[12:15], s[40:41] sc1
    s_mov_b64 exec, -1
    s_cmp_lt_u32 s42, 28
    s_cselect_b32 s14, s49, 0
    s_add_u32 s12, s14, s48
    v_mov_b32 v4, s12
    ds_write_b32 v1, v4 offset:8
    s_mov_b32 s60, 0
L_w_31:
    ds_read_b32 v8, v1 offset:0
    s_waitcnt lgkmcnt(0)
    v_readfirstlane_b32 s61, v8
    s_cmp_ge_i32 s61, 39
    s_cbranch_scc1 L_d_32
    s_sleep 1
    s_add_u32 s60, s60, 1
    s_cmp_lt_u32 s60, 1000000
    s_cbranch_scc1 L_w_31
    s_endpgm
L_padA_3:
    s_branch L_padA_4
L_d_32:
    s_mov_b32 s60, 0
L_qg_33:
    global_load_dwordx4 v[16:19], v6, s[40:41] offset:0 sc1
    global_load_dwordx4 v[20:23], v6, s[40:41] offset:1024 sc1
    s_waitcnt vmcnt(0)
    v_max3_u32 v10, v16, v17, v18
    v_max3_u32 v10, v10, v19, v20
    v_max3_u32 v10, v10, v21, v22
    v_max_u32 v10, v10, v23
    v_cmp_eq_u32 vcc, -1, v10
    s_cbranch_vccz L_qgd_34
    s_sleep 8
    s_add_u32 s60, s60, 1
    s_cmp_lt_u32 s60, 1000000
    s_cbranch_scc1 L_qg_33
    s_endpgm
L_padA_4:
    s_branch L_padA_5
L_qgd_34:
    v_add_f32 v16, v16, v20
    v_add_f32 v17, v17, v21
    v_add_f32 v18, v18, v22
    v_add_f32 v19, v19, v23
    v_mov_b32 v20, v16
    v_mov_b32 v21, v17
    v_mov_b32 v22, v18
    v_mov_b32 v23, v19
    s_nop 1
    v_permlane32_swap_b32 v16, v20
    v_permlane32_swap_b32 v17, v21
    v_permlane32_swap_b32 v18, v22
    v_permlane32_swap_b32 v19, v23
    s_nop 1
    v_add_f32 v16, v16, v20
    v_add_f32 v17, v17, v21
    v_add_f32 v18, v18, v22
    v_add_f32 v19, v19, v23
    v_cvt_pk_bf16_f32 v16, v16, v17
    v_cvt_pk_bf16_f32 v17, v18, v19
    v_and_b32 v8, 31, v0
    v_lshl_add_u32 v8, v8, 3, v1
    v_mov_b32 v10, 1
    ds_write_b64 v8, v[16:17] offset:256
    ds_write_b32 v1, v10 offset:80
    ds_write_b32 v1, v10 offset:32
    s_mov_b32 s7, 52
    s_and_b32 s9, s2, 7
    s_mul_i32 s9, s9, 5
    s_lshr_b32 s61, s2, 3
    s_add_u32 s9, s9, s61
    s_and_b32 s9, s9, 31
    s_mov_b32 s43, 0
    s_mov_b32 s8, 0
    s_mov_b32 s6, 0
    v_mov_b32 v5, -150
L_t_loop:
    s_mov_b32 s60, 0
L_w_35:
    ds_read_b32 v8, v1 offset:0
    s_waitcnt lgkmcnt(0)
    v_readfirstlane_b32 s61, v8
    s_cmp_ge_i32 s61, s7
    s_cbranch_scc1 L_d_36
    s_sleep 1
    s_add_u32 s60, s60, 1
    s_cmp_lt_u32 s60, 1000000
    s_cbranch_scc1 L_w_35
    s_endpgm
L_padA_5:
    s_branch L_padA_6
L_d_36:
    s_memrealtime s[10:11]
    s_add_u32 s7, s7, 16
    s_waitcnt lgkmcnt(0)
    s_min_u32 s10, s10, -2
    v_mov_b32 v12, s10
    s_cmp_eq_u32 s9, 13
    s_cbranch_scc0 L_t_nr
    s_mov_b32 exec_lo, -1
    s_mov_b32 exec_hi, 0
    global_store_dword v2, v12, s[40:41] sc1
    s_mov_b64 exec, -1
L_t_nr:
    s_mov_b32 s60, 0
L_w_37:
    ds_read_b32 v8, v1 offset:0
    s_waitcnt lgkmcnt(0)
    v_readfirstlane_b32 s61, v8
    s_cmp_ge_i32 s61, s7
    s_cbranch_scc1 L_d_38
    s_sleep 2
    s_add_u32 s60, s60, 1
    s_cmp_lt_u32 s60, 1000000
    s_cbranch_scc1 L_w_37
    s_endpgm
L_padA_6:
    s_branch L_padA_7
L_d_38:
    global_load_dword v4, v3, s[40:41] sc1
    v_add_u32 v2, 1024, v2
    v_add_u32 v3, 1024, v3
    s_cmp_lt_u32 s7, 256
    s_cselect_b32 s13, s14, 0
    s_add_u32 s13, s13, s48
    s_add_u32 s7, s7, 16
    s_waitcnt vmcnt(0)
    v_cmp_eq_u32 vcc, -1, v4
    v_sub_u32 v4, v12, v4
    s_nop 0
    v_cndmask_b32 v4, v4, v5, vcc
    v_mov_b32 v6, v4
    s_nop 1
    v_min_i32_dpp v6, v6, v6 row_ror:1 row_mask:0xf bank_mask:0xf
    s_nop 1
    v_min_i32_dpp v6, v6, v6 row_ror:2 row_mask:0xf bank_mask:0xf
    s_nop 1
    v_min_i32_dpp v6, v6, v6 row_ror:4 row_mask:0xf bank_mask:0xf
    s_nop 1
    v_add_u32_dpp v4, v4, v4 row_ror:1 row_mask:0xf bank_mask:0xf
    s_nop 1
    v_add_u32_dpp v4, v4, v4 row_ror:2 row_mask:0xf bank_mask:0xf
    s_nop 1
    v_add_u32_dpp v4, v4, v4 row_ror:4 row_mask:0xf bank_mask:0xf
    s_nop 0
    v_readfirstlane_b32 s12, v4
    s_max_i32 s12, s12, -100000
    s_min_i32 s12, s12, 100000
    v_readfirstlane_b32 s47, v6
    s_lshl_b32 s47, s47, 3
    s_sub_u32 s47, s47, s12
    s_max_i32 s47, s47, -100000
    s_mul_i32 s61, s47, 20
    s_ashr_i32 s61, s61, 11
    s_add_u32 s13, s13, s61
    s_lshl_b32 s15, s10, 3
    s_sub_u32 s15, s15, s12
    s_sub_u32 s46, s15, s43
    s_mov_b32 s43, s15
    s_mul_i32 s12, s12, s50
    s_ashr_i32 s12, s12, 11
    s_add_u32 s12, s12, s13
    v_mov_b32 v4, s12
    ds_write_b32 v1, v4 offset:8
    s_cmp_le_u32 s7, 436
    s_cbranch_scc1 L_t_loop
    s_mul_i32 s46, s46, 1024
    s_lshr_b32 s46, s46, 10
    s_sub_u32 s46, s46, 0
    s_lshl_b32 s43, s43, 5
    s_mul_i32 s61, s46, 24
    s_add_u32 s43, s43, s61
    s_lshl_b32 s46, s46, 1
    s_mov_b32 s7, 460
L_e_loop:
    s_mov_b32 s60, 0
L_w_39:
    ds_read_b32 v8, v1 offset:0
    s_waitcnt lgkmcnt(0)
    v_readfirstlane_b32 s61, v8
    s_cmp_ge_i32 s61, s7
    s_cbranch_scc1 L_d_40
    s_sleep 1
    s_add_u32 s60, s60, 1
    s_cmp_lt_u32 s60, 1000000
    s_cbranch_scc1 L_w_39
    s_endpgm
L_padA_7:
    s_branch L_padA_8
L_d_40:
    s_memrealtime s[10:11]
    s_add_u32 s7, s7, 2
    s_waitcnt lgkmcnt(0)
    s_lshl_b32 s12, s10, 8
    s_sub_u32 s12, s12, s43
    s_add_u32 s43, s43, s46
    s_ashr_i32 s12, s12, 5
    s_max_i32 s12, s12, -100000
    s_min_i32 s12, s12, 100000
    s_mul_i32 s12, s12, 115
    s_ashr_i32 s12, s12, 11
    s_add_u32 s12, s12, s13
    v_mov_b32 v4, s12
    ds_write_b32 v1, v4 offset:8
    s_cmp_lt_u32 s7, 502
    s_cbranch_scc1 L_e_loop
    s_endpgm
L_padA_8:
    s_branch L_pad_back
L_aux:
    v_and_b32 v8, 1, v0
    v_cmp_eq_u32 vcc, 1, v8
    v_mov_b32 v9, 0x0c0c0100
    v_mov_b32 v10, 0x01000c0c
    v_mov_b32 v11, 0x0c0c0302
    v_mov_b32 v12, 0x03020c0c
    v_mov_b32 v13, 0x0c0c0c0c
    v_bfe_u32 v8, v0, 1, 2
    v_cndmask_b32 v9, v9, v10, vcc
    v_cndmask_b32 v11, v11, v12, vcc
    v_cmp_eq_u32 vcc, 0, v8
    s_nop 1
    v_cndmask_b32 v240, v13, v9, vcc
    v_cndmask_b32 v244, v13, v11, vcc
    v_cmp_eq_u32 vcc, 1, v8
    s_nop 1
    v_cndmask_b32 v241, v13, v9, vcc
    v_cndmask_b32 v245, v13, v11, vcc
    v_cmp_eq_u32 vcc, 2, v8
    s_nop 1
    v_cndmask_b32 v242, v13, v9, vcc
    v_cndmask_b32 v246, v13, v11, vcc
    v_cmp_eq_u32 vcc, 3, v8
    s_nop 1
    v_cndmask_b32 v243, v13, v9, vcc
    v_cndmask_b32 v247, v13, v11, vcc
    v_and_b32 v11, 7, v0
    v_mov_b32 v4, 0
    v_mov_b32 v5, 0
    v_mov_b32 v6, 0
    v_mov_b32 v7, 0
    s_mov_b32 s12, 0xbfb8aa3b
    s_mov_b32 s52, s32
    s_mov_b32 s53, s33
    s_mov_b32 s54, 0x1c0000
    s_mov_b32 s55, 0x20000
    s_cmp_lt_u32 s42, 28
    s_cbranch_scc0 L_a_gate
    s_mov_b32 s7, 0
    s_mov_b32 s9, 0
    s_mov_b32 s8, s43
    v_lshlrev_b32 v2, 7, v2
    s_lshl_b32 s11, s5, 4
    v_add_u32 v9, s11, v2
    global_load_dwordx4 v[20:23], v9, s[16:17]
    s_waitcnt vmcnt(0)
    v_mov_b32 v12, 0
    v_mov_b32 v13, 0
    v_mov_b32 v14, 0
    v_mov_b32 v15, 0
    v_mov_b32 v16, 0
    v_mov_b32 v17, 0
    v_mov_b32 v18, 0
    v_mov_b32 v19, 0
    s_branch L_f_j
L_f_loop:
    s_xor_b32 s10, s9, s5
    s_lshl_b32 s11, s10, 4
    v_add_u32 v9, s11, v2
    s_mul_i32 s10, s10, 28672
    s_add_u32 s10, s10, s8
    s_mov_b32 s60, 0
L_w_41:
    ds_read_b32 v8, v1 offset:0
    s_waitcnt lgkmcnt(0)
    v_readfirstlane_b32 s61, v8
    s_cmp_ge_i32 s61, s7
    s_cbranch_scc1 L_d_42
    s_sleep 2
    s_add_u32 s60, s60, 1
    s_cmp_lt_u32 s60, 1000000
    s_cbranch_scc1 L_w_41
    s_endpgm
L_d_42:
    global_load_dwordx4 v[20:23], v9, s[16:17]
    s_waitcnt vmcnt(4)
    buffer_load_dwordx4 v[128:131], v3, s[44:47], s10 offen
    s_waitcnt vmcnt(4)
    buffer_load_dwordx4 v[132:135], v3, s[48:51], s10 offen
    s_addk_i32 s10, 3584
    s_waitcnt vmcnt(4)
    buffer_load_dwordx4 v[136:139], v3, s[44:47], s10 offen
    s_waitcnt vmcnt(4)
    buffer_load_dwordx4 v[140:143], v3, s[48:51], s10 offen
    s_addk_i32 s10, 3584
    s_waitcnt vmcnt(4)
    buffer_load_dwordx4 v[144:147], v3, s[44:47], s10 offen
    s_waitcnt vmcnt(4)
    buffer_load_dwordx4 v[148:151], v3, s[48:51], s10 offen
    s_addk_i32 s10, 3584
    s_waitcnt vmcnt(4)
    buffer_load_dwordx4 v[152:155], v3, s[44:47], s10 offen
    s_waitcnt vmcnt(4)
    buffer_load_dwordx4 v[156:159], v3, s[48:51], s10 offen
    s_addk_i32 s10, 3584
    s_waitcnt vmcnt(4)
    buffer_load_dwordx4 v[160:163], v3, s[44:47], s10 offen
    s_waitcnt vmcnt(4)
    buffer_load_dwordx4 v[164:167], v3, s[48:51], s10 offen
    s_addk_i32 s10, 3584
    s_waitcnt vmcnt(4)
    buffer_load_dwordx4 v[168:171], v3, s[44:47], s10 offen
    s_waitcnt vmcnt(4)
    buffer_load_dwordx4 v[172:175], v3, s[48:51], s10 offen
    s_addk_i32 s10, 3584
    s_waitcnt vmcnt(4)
    buffer_load_dwordx4 v[176:179], v3, s[44:47], s10 offen
    s_waitcnt vmcnt(4)
    buffer_load_dwordx4 v[180:183], v3, s[48:51], s10 offen
    s_addk_i32 s10, 3584
    s_waitcnt vmcnt(4)
    buffer_load_dwordx4 v[184:187], v3, s[44:47], s10 offen
    s_waitcnt vmcnt(4)
    buffer_load_dwordx4 v[188:191], v3, s[48:51], s10 offen
    s_addk_i32 s10, 3584
L_f_j:
    s_add_u32 s9, s9, 1
    s_add_u32 s7, s7, 32
    s_waitcnt vmcnt(16)
    v_perm_b32 v64, v20, v20, v240
    v_perm_b32 v65, v20, v20, v241
    v_perm_b32 v66, v20, v20, v242
    v_perm_b32 v67, v20, v20, v243
    v_perm_b32 v68, v20, v20, v244
    v_perm_b32 v69, v20, v20, v245
    v_perm_b32 v70, v20, v20, v246
    v_perm_b32 v71, v20, v20, v247
    v_perm_b32 v72, v21, v21, v240
    v_perm_b32 v73, v21, v21, v241
    v_perm_b32 v74, v21, v21, v242
    v_perm_b32 v75, v21, v21, v243
    v_perm_b32 v76, v21, v21, v244
    v_perm_b32 v77, v21, v21, v245
    v_perm_b32 v78, v21, v21, v246
    v_perm_b32 v79, v21, v21, v247
    v_perm_b32 v80, v22, v22, v240
    v_perm_b32 v81, v22, v22, v241
    v_perm_b32 v82, v22, v22, v242
    v_perm_b32 v83, v22, v22, v243
    v_perm_b32 v84, v22, v22, v244
    v_perm_b32 v85, v22, v22, v245
    v_perm_b32 v86, v22, v22, v246
    v_perm_b32 v87, v22, v22, v247
    v_perm_b32 v88, v23, v23, v240
    v_perm_b32 v89, v23, v23, v241
    v_perm_b32 v90, v23, v23, v242
    v_perm_b32 v91, v23, v23, v243
    v_perm_b32 v92, v23, v23, v244
    v_perm_b32 v93, v23, v23, v245
    v_perm_b32 v94, v23, v23, v246
    v_perm_b32 v95, v23, v23, v247
    s_waitcnt vmcnt(0)
    v_mfma_f32_16x16x32_bf16 v[12:15], v[64:67], v[128:131], v[12:15]
    v_mfma_f32_16x16x32_bf16 v[16:19], v[64:67], v[132:135], v[16:19]
    v_mfma_f32_16x16x32_bf16 v[12:15], v[68:71], v[136:139], v[12:15]
    v_mfma_f32_16x16x32_bf16 v[16:19], v[68:71], v[140:143], v[16:19]
    v_mfma_f32_16x16x32_bf16 v[12:15], v[72:75], v[144:147], v[12:15]
    v_mfma_f32_16x16x32_bf16 v[16:19], v[72:75], v[148:151], v[16:19]
    v_mfma_f32_16x16x32_bf16 v[12:15], v[76:79], v[152:155], v[12:15]
    v_mfma_f32_16x16x32_bf16 v[16:19], v[76:79], v[156:159], v[16:19]
    v_mfma_f32_16x16x32_bf16 v[12:15], v[80:83], v[160:163], v[12:15]
    v_mfma_f32_16x16x32_bf16 v[16:19], v[80:83], v[164:167], v[16:19]
    v_mfma_f32_16x16x32_bf16 v[12:15], v[84:87], v[168:171], v[12:15]
    v_mfma_f32_16x16x32_bf16 v[16:19], v[84:87], v[172:175], v[16:19]
    v_mfma_f32_16x16x32_bf16 v[12:15], v[88:91], v[176:179], v[12:15]
    v_mfma_f32_16x16x32_bf16 v[16:19], v[88:91], v[180:183], v[16:19]
    v_mfma_f32_16x16x32_bf16 v[12:15], v[92:95], v[184:187], v[12:15]
    v_mfma_f32_16x16x32_bf16 v[16:19], v[92:95], v[188:191], v[16:19]
    s_cmp_lt_u32 s9, 8
    s_cbranch_scc1 L_f_loop
    s_nop 5
    v_permlane32_swap_b32 v12, v24
    v_permlane32_swap_b32 v13, v25
    v_permlane32_swap_b32 v14, v26
    v_permlane32_swap_b32 v15, v27
    v_permlane32_swap_b32 v16, v28
    v_permlane32_swap_b32 v17, v29
    v_permlane32_swap_b32 v18, v30
    v_permlane32_swap_b32 v19, v31
    s_nop 1
    v_add_f32_dpp v12, v24, v12 row_ror:8 row_mask:0xf bank_mask:0xf
    v_add_f32_dpp v13, v25, v13 row_ror:8 row_mask:0xf bank_mask:0xf
    v_add_f32_dpp v14, v26, v14 row_ror:8 row_mask:0xf bank_mask:0xf
    v_add_f32_dpp v15, v27, v15 row_ror:8 row_mask:0xf bank_mask:0xf
    v_add_f32_dpp v16, v28, v16 row_ror:8 row_mask:0xf bank_mask:0xf
    v_add_f32_dpp v17, v29, v17 row_ror:8 row_mask:0xf bank_mask:0xf
    v_add_f32_dpp v18, v30, v18 row_ror:8 row_mask:0xf bank_mask:0xf
    v_add_f32_dpp v19, v31, v19 row_ror:8 row_mask:0xf bank_mask:0xf
    v_cvt_pk_bf16_f32 v12, v12, v12
    v_and_b32 v12, 0xffff0000, v12
    v_cvt_pk_bf16_f32 v13, v13, v13
    v_and_b32 v13, 0xffff0000, v13
    v_cvt_pk_bf16_f32 v14, v14, v14
    v_and_b32 v14, 0xffff0000, v14
    v_cvt_pk_bf16_f32 v15, v15, v15
    v_and_b32 v15, 0xffff0000, v15
    v_cvt_pk_bf16_f32 v16, v16, v16
    v_and_b32 v16, 0xffff0000, v16
    v_cvt_pk_bf16_f32 v17, v17, v17
    v_and_b32 v17, 0xffff0000, v17
    v_cvt_pk_bf16_f32 v18, v18, v18
    v_and_b32 v18, 0xffff0000, v18
    v_cvt_pk_bf16_f32 v19, v19, v19
    v_and_b32 v19, 0xffff0000, v19
    v_mul_f32 v20, s12, v12
    v_mul_f32 v21, s12, v13
    v_mul_f32 v22, s12, v14
    v_mul_f32 v23, s12, v15
    v_exp_f32 v20, v20
    v_exp_f32 v21, v21
    v_exp_f32 v22, v22
    v_exp_f32 v23, v23
    s_nop 0
    v_add_f32 v20, 1.0, v20
    v_add_f32 v21, 1.0, v21
    v_add_f32 v22, 1.0, v22
    v_add_f32 v23, 1.0, v23
    v_rcp_f32 v20, v20
    v_rcp_f32 v21, v21
    v_rcp_f32 v22, v22
    v_rcp_f32 v23, v23
    s_nop 0
    v_mul_f32 v12, v12, v20
    v_mul_f32 v13, v13, v21
    v_mul_f32 v14, v14, v22
    v_mul_f32 v15, v15, v23
    v_cvt_pk_bf16_f32 v12, v12, v12
    v_and_b32 v12, 0xffff0000, v12
    v_cvt_pk_bf16_f32 v13, v13, v13
    v_and_b32 v13, 0xffff0000, v13
    v_cvt_pk_bf16_f32 v14, v14, v14
    v_and_b32 v14, 0xffff0000, v14
    v_cvt_pk_bf16_f32 v15, v15, v15
    v_and_b32 v15, 0xffff0000, v15
    v_mul_f32 v12, v12, v16
    v_mul_f32 v13, v13, v17
    v_mul_f32 v14, v14, v18
    v_mul_f32 v15, v15, v19
    v_cvt_pk_bf16_f32 v12, v12, v13
    v_cvt_pk_bf16_f32 v13, v14, v15
    v_lshrrev_b32 v9, 4, v0
    v_lshlrev_b32 v8, 4, v11
    v_lshl_add_u32 v8, v9, 3, v8
    v_add_u32 v8, v8, v1
    v_lshrrev_b32 v9, 3, v0
    v_lshl_add_u32 v9, v9, 4, v1
    s_mov_b32 exec_lo, 0x00ff00ff
    s_mov_b32 exec_hi, 0
    ds_write_b64 v8, v[12:13] offset:512
    s_mov_b64 exec, -1
    s_waitcnt lgkmcnt(0)
    ds_read_b128 v[20:23], v9 offset:512
    s_waitcnt lgkmcnt(0)
    v_perm_b32 v160, v20, v20, v240
    v_perm_b32 v161, v20, v20, v241
    v_perm_b32 v162, v20, v20, v242
    v_perm_b32 v163, v20, v20, v243
    v_perm_b32 v164, v20, v20, v244
    v_perm_b32 v165, v20, v20, v245
    v_perm_b32 v166, v20, v20, v246
    v_perm_b32 v167, v20, v20, v247
    v_perm_b32 v168, v21, v21, v240
    v_perm_b32 v169, v21, v21, v241
    v_perm_b32 v170, v21, v21, v242
    v_perm_b32 v171, v21, v21, v243
    v_perm_b32 v172, v21, v21, v244
    v_perm_b32 v173, v21, v21, v245
    v_perm_b32 v174, v21, v21, v246
    v_perm_b32 v175, v21, v21, v247
    v_perm_b32 v176, v22, v22, v240
    v_perm_b32 v177, v22, v22, v241
    v_perm_b32 v178, v22, v22, v242
    v_perm_b32 v179, v22, v22, v243
    v_perm_b32 v180, v22, v22, v244
    v_perm_b32 v181, v22, v22, v245
    v_perm_b32 v182, v22, v22, v246
    v_perm_b32 v183, v22, v22, v247
    v_perm_b32 v184, v23, v23, v240
    v_perm_b32 v185, v23, v23, v241
    v_perm_b32 v186, v23, v23, v242
    v_perm_b32 v187, v23, v23, v243
    v_perm_b32 v188, v23, v23, v244
    v_perm_b32 v189, v23, v23, v245
    v_perm_b32 v190, v23, v23, v246
    v_perm_b32 v191, v23, v23, v247
    v_mov_b32 v4, -1
    v_mov_b32 v5, -1
    v_mov_b32 v6, -1
    v_mov_b32 v7, -1
L_a_gate:
    v_lshlrev_b32 v9, 4, v0
    global_load_dwordx4 v[20:23], v9, s[16:17]
    global_load_dwordx4 v[24:27], v9, s[34:35]
    s_waitcnt vmcnt(0)
    v_lshlrev_b32 v28, 16, v20
    v_and_b32 v29, 0xffff0000, v20
    v_lshlrev_b32 v36, 16, v24
    v_and_b32 v37, 0xffff0000, v24
    v_lshlrev_b32 v30, 16, v21
    v_and_b32 v31, 0xffff0000, v21
    v_lshlrev_b32 v38, 16, v25
    v_and_b32 v39, 0xffff0000, v25
    v_lshlrev_b32 v32, 16, v22
    v_and_b32 v33, 0xffff0000, v22
    v_lshlrev_b32 v40, 16, v26
    v_and_b32 v41, 0xffff0000, v26
    v_lshlrev_b32 v34, 16, v23
    v_and_b32 v35, 0xffff0000, v23
    v_lshlrev_b32 v42, 16, v27
    v_and_b32 v43, 0xffff0000, v27
    v_mul_f32 v28, v28, v36
    v_mul_f32 v29, v29, v37
    v_mul_f32 v30, v30, v38
    v_mul_f32 v31, v31, v39
    v_mul_f32 v32, v32, v40
    v_mul_f32 v33, v33, v41
    v_mul_f32 v34, v34, v42
    v_mul_f32 v35, v35, v43
    v_cvt_pk_bf16_f32 v28, v28, v28
    v_and_b32 v28, 0xffff0000, v28
    v_cvt_pk_bf16_f32 v29, v29, v29
    v_and_b32 v29, 0xffff0000, v29
    v_cvt_pk_bf16_f32 v30, v30, v30
    v_and_b32 v30, 0xffff0000, v30
    v_cvt_pk_bf16_f32 v31, v31, v31
    v_and_b32 v31, 0xffff0000, v31
    v_cvt_pk_bf16_f32 v32, v32, v32
    v_and_b32 v32, 0xffff0000, v32
    v_cvt_pk_bf16_f32 v33, v33, v33
    v_and_b32 v33, 0xffff0000, v33
    v_cvt_pk_bf16_f32 v34, v34, v34
    v_and_b32 v34, 0xffff0000, v34
    v_cvt_pk_bf16_f32 v35, v35, v35
    v_and_b32 v35, 0xffff0000, v35
    v_add_f32 v28, v28, v32
    v_add_f32 v29, v29, v33
    v_add_f32 v30, v30, v34
    v_add_f32 v31, v31, v35
    v_add_f32 v28, v28, v29
    v_add_f32 v30, v30, v31
    v_add_f32 v28, v28, v30
    s_nop 1
    v_add_f32_dpp v28, v28, v28 row_ror:1 row_mask:0xf bank_mask:0xf
    s_nop 1
    v_add_f32_dpp v28, v28, v28 row_ror:2 row_mask:0xf bank_mask:0xf
    s_nop 1
    v_add_f32_dpp v28, v28, v28 row_ror:4 row_mask:0xf bank_mask:0xf
    s_nop 1
    v_add_f32_dpp v28, v28, v28 row_ror:8 row_mask:0xf bank_mask:0xf
    v_mov_b32 v29, v28
    s_nop 1
    v_permlane16_swap_b32 v28, v29
    s_nop 1
    v_add_f32 v28, v28, v29
    v_mov_b32 v29, v28
    s_nop 1
    v_permlane32_swap_b32 v28, v29
    s_nop 1
    v_add_f32 v28, v28, v29
    v_cvt_pk_bf16_f32 v28, v28, v28
    v_and_b32 v28, 0xffff0000, v28
    v_mul_f32 v28, s12, v28
    v_exp_f32 v28, v28
    s_nop 0
    v_add_f32 v28, 1.0, v28
    v_rcp_f32 v2, v28
    s_nop 0
    v_cvt_pk_bf16_f32 v2, v2, v2
    v_and_b32 v2, 0xffff0000, v2
    v_sub_f32 v3, 1.0, v2
    v_cvt_pk_bf16_f32 v3, v3, v3
    v_and_b32 v3, 0xffff0000, v3
L_a_mid:
    s_mov_b32 s12, 0x3fb8aa3b
    v_and_b32 v8, 7, v0
    v_and_b32 v9, 16, v0
    v_lshl_add_u32 v8, v8, 5, v9
    v_add_u32 v224, v8, v1
    s_mov_b64 exec, 0x00ff00ff
    ds_write_b128 v224, v[4:7] offset:640
    s_mov_b64 exec, -1
    v_lshl_add_u32 v8, v0, 4, v1
    s_mov_b32 s60, 0
L_w_43:
    ds_read_b32 v12, v1 offset:32
    s_waitcnt lgkmcnt(0)
    v_readfirstlane_b32 s61, v12
    s_cmp_lg_u32 s61, 0
    s_cbranch_scc1 L_d_44
    s_sleep 2
    s_add_u32 s60, s60, 1
    s_cmp_lt_u32 s60, 1000000
    s_cbranch_scc1 L_w_43
    s_endpgm
L_padE_0:
    s_branch L_padE_1
L_d_44:
    s_mov_b32 s60, 0
L_w_45:
    ds_read_b96 v[12:14], v1 offset:64
    s_waitcnt lgkmcnt(0)
    v_add3_u32 v12, v12, v13, v14
    s_nop 0
    v_readfirstlane_b32 s61, v12
    s_cmp_eq_u32 s61, 3
    s_cbranch_scc1 L_d_46
    s_sleep 1
    s_add_u32 s60, s60, 1
    s_cmp_lt_u32 s60, 1000000
    s_cbranch_scc1 L_w_45
    s_endpgm
L_padE_1:
    s_branch L_padE_2
L_d_46:
    ds_read_b128 v[16:19], v8 offset:1024
    ds_read_b128 v[20:23], v8 offset:2048
    ds_read_b128 v[24:27], v8 offset:3072
    ds_read_b128 v[28:31], v8 offset:4096
    ds_read_b128 v[32:35], v8 offset:5120
    ds_read_b128 v[36:39], v8 offset:6144
    ds_read_b128 v[40:43], v8 offset:7168
    ds_read_b128 v[44:47], v8 offset:8192
    s_waitcnt lgkmcnt(7)
    v_lshlrev_b32 v64, 16, v16
    v_and_b32 v65, 0xffff0000, v16
    v_lshlrev_b32 v66, 16, v17
    v_and_b32 v67, 0xffff0000, v17
    v_lshlrev_b32 v68, 16, v18
    v_and_b32 v69, 0xffff0000, v18
    v_lshlrev_b32 v70, 16, v19
    v_and_b32 v71, 0xffff0000, v19
    v_max_f32 v12, v64, v65
    v_max_f32 v13, v66, v67
    v_max3_f32 v12, v12, v68, v69
    v_max3_f32 v13, v13, v70, v71
    s_waitcnt lgkmcnt(6)
    v_lshlrev_b32 v72, 16, v20
    v_and_b32 v73, 0xffff0000, v20
    v_lshlrev_b32 v74, 16, v21
    v_and_b32 v75, 0xffff0000, v21
    v_lshlrev_b32 v76, 16, v22
    v_and_b32 v77, 0xffff0000, v22
    v_lshlrev_b32 v78, 16, v23
    v_and_b32 v79, 0xffff0000, v23
    v_max3_f32 v12, v12, v72, v73
    v_max3_f32 v13, v13, v74, v75
    v_max3_f32 v12, v12, v76, v77
    v_max3_f32 v13, v13, v78, v79
    s_waitcnt lgkmcnt(5)
    v_lshlrev_b32 v80, 16, v24
    v_and_b32 v81, 0xffff0000, v24
    v_lshlrev_b32 v82, 16, v25
    v_and_b32 v83, 0xffff0000, v25
    v_lshlrev_b32 v84, 16, v26
    v_and_b32 v85, 0xffff0000, v26
    v_lshlrev_b32 v86, 16, v27
    v_and_b32 v87, 0xffff0000, v27
    v_max3_f32 v12, v12, v80, v81
    v_max3_f32 v13, v13, v82, v83
    v_max3_f32 v12, v12, v84, v85
    v_max3_f32 v13, v13, v86, v87
    s_waitcnt lgkmcnt(4)
    v_lshlrev_b32 v88, 16, v28
    v_and_b32 v89, 0xffff0000, v28
    v_lshlrev_b32 v90, 16, v29
    v_and_b32 v91, 0xffff0000, v29
    v_lshlrev_b32 v92, 16, v30
    v_and_b32 v93, 0xffff0000, v30
    v_lshlrev_b32 v94, 16, v31
    v_and_b32 v95, 0xffff0000, v31
    v_max3_f32 v12, v12, v88, v89
    v_max3_f32 v13, v13, v90, v91
    v_max3_f32 v12, v12, v92, v93
    v_max3_f32 v13, v13, v94, v95
    s_waitcnt lgkmcnt(3)
    v_lshlrev_b32 v96, 16, v32
    v_and_b32 v97, 0xffff0000, v32
    v_lshlrev_b32 v98, 16, v33
    v_and_b32 v99, 0xffff0000, v33
    v_lshlrev_b32 v100, 16, v34
    v_and_b32 v101, 0xffff0000, v34
    v_lshlrev_b32 v102, 16, v35
    v_and_b32 v103, 0xffff0000, v35
    v_max3_f32 v12, v12, v96, v97
    v_max3_f32 v13, v13, v98, v99
    v_max3_f32 v12, v12, v100, v101
    v_max3_f32 v13, v13, v102, v103
    s_waitcnt lgkmcnt(2)
    v_lshlrev_b32 v104, 16, v36
    v_and_b32 v105, 0xffff0000, v36
    v_lshlrev_b32 v106, 16, v37
    v_and_b32 v107, 0xffff0000, v37
    v_lshlrev_b32 v108, 16, v38
    v_and_b32 v109, 0xffff0000, v38
    v_lshlrev_b32 v110, 16, v39
    v_and_b32 v111, 0xffff0000, v39
    v_max3_f32 v12, v12, v104, v105
    v_max3_f32 v13, v13, v106, v107
    v_max3_f32 v12, v12, v108, v109
    v_max3_f32 v13, v13, v110, v111
    s_waitcnt lgkmcnt(1)
    v_lshlrev_b32 v112, 16, v40
    v_and_b32 v113, 0xffff0000, v40
    v_lshlrev_b32 v114, 16, v41
    v_and_b32 v115, 0xffff0000, v41
    v_lshlrev_b32 v116, 16, v42
    v_and_b32 v117, 0xffff0000, v42
    v_lshlrev_b32 v118, 16, v43
    v_and_b32 v119, 0xffff0000, v43
    v_max3_f32 v12, v12, v112, v113
    v_max3_f32 v13, v13, v114, v115
    v_max3_f32 v12, v12, v116, v117
    v_max3_f32 v13, v13, v118, v119
    s_waitcnt lgkmcnt(0)
    v_lshlrev_b32 v120, 16, v44
    v_and_b32 v121, 0xffff0000, v44
    v_lshlrev_b32 v122, 16, v45
    v_and_b32 v123, 0xffff0000, v45
    v_lshlrev_b32 v124, 16, v46
    v_and_b32 v125, 0xffff0000, v46
    v_lshlrev_b32 v126, 16, v47
    v_and_b32 v127, 0xffff0000, v47
    v_max3_f32 v12, v12, v120, v121
    v_max3_f32 v13, v13, v122, v123
    v_max3_f32 v12, v12, v124, v125
    v_max3_f32 v13, v13, v126, v127
    v_max_f32 v12, v12, v13
    s_nop 1
    v_max_f32_dpp v12, v12, v12 row_ror:1 row_mask:0xf bank_mask:0xf
    s_nop 1
    v_max_f32_dpp v12, v12, v12 row_ror:2 row_mask:0xf bank_mask:0xf
    s_nop 1
    v_max_f32_dpp v12, v12, v12 row_ror:4 row_mask:0xf bank_mask:0xf
    s_nop 1
    v_max_f32_dpp v12, v12, v12 row_ror:8 row_mask:0xf bank_mask:0xf
    v_mov_b32 v13, v12
    s_nop 1
    v_permlane16_swap_b32 v12, v13
    s_nop 1
    v_max_f32 v12, v12, v13
    v_mov_b32 v13, v12
    s_nop 1
    v_permlane32_swap_b32 v12, v13
    s_nop 1
    v_max_f32 v12, v12, v13
    v_mul_f32 v14, s12, v12
    v_mov_b32 v13, 0
    v_mov_b32 v15, 0
    v_fma_f32 v64, v64, s12, -v14
    v_fma_f32 v65, v65, s12, -v14
    v_fma_f32 v66, v66, s12, -v14
    v_fma_f32 v67, v67, s12, -v14
    v_fma_f32 v68, v68, s12, -v14
    v_fma_f32 v69, v69, s12, -v14
    v_fma_f32 v70, v70, s12, -v14
    v_fma_f32 v71, v71, s12, -v14
    v_exp_f32 v64, v64
    v_exp_f32 v65, v65
    v_exp_f32 v66, v66
    v_exp_f32 v67, v67
    v_exp_f32 v68, v68
    v_exp_f32 v69, v69
    v_exp_f32 v70, v70
    v_exp_f32 v71, v71
    v_cvt_pk_bf16_f32 v128, v64, v65
    v_cvt_pk_bf16_f32 v129, v66, v67
    v_cvt_pk_bf16_f32 v130, v68, v69
    v_cvt_pk_bf16_f32 v131, v70, v71
    ds_write_b128 v8, v[128:131] offset:1024
    v_add_f32 v13, v13, v64
    v_add_f32 v15, v15, v65
    v_add_f32 v13, v13, v66
    v_add_f32 v15, v15, v67
    v_add_f32 v13, v13, v68
    v_add_f32 v15, v15, v69
    v_add_f32 v13, v13, v70
    v_add_f32 v15, v15, v71
    v_fma_f32 v72, v72, s12, -v14
    v_fma_f32 v73, v73, s12, -v14
    v_fma_f32 v74, v74, s12, -v14
    v_fma_f32 v75, v75, s12, -v14
    v_fma_f32 v76, v76, s12, -v14
    v_fma_f32 v77, v77, s12, -v14
    v_fma_f32 v78, v78, s12, -v14
    v_fma_f32 v79, v79, s12, -v14
    v_exp_f32 v72, v72
    v_exp_f32 v73, v73
    v_exp_f32 v74, v74
    v_exp_f32 v75, v75
    v_exp_f32 v76, v76
    v_exp_f32 v77, v77
    v_exp_f32 v78, v78
    v_exp_f32 v79, v79
    v_cvt_pk_bf16_f32 v132, v72, v73
    v_cvt_pk_bf16_f32 v133, v74, v75
    v_cvt_pk_bf16_f32 v134, v76, v77
    v_cvt_pk_bf16_f32 v135, v78, v79
    ds_write_b128 v8, v[132:135] offset:2048
    v_add_f32 v13, v13, v72
    v_add_f32 v15, v15, v73
    v_add_f32 v13, v13, v74
    v_add_f32 v15, v15, v75
    v_add_f32 v13, v13, v76
    v_add_f32 v15, v15, v77
    v_add_f32 v13, v13, v78
    v_add_f32 v15, v15, v79
    v_fma_f32 v80, v80, s12, -v14
    v_fma_f32 v81, v81, s12, -v14
    v_fma_f32 v82, v82, s12, -v14
    v_fma_f32 v83, v83, s12, -v14
    v_fma_f32 v84, v84, s12, -v14
    v_fma_f32 v85, v85, s12, -v14
    v_fma_f32 v86, v86, s12, -v14
    v_fma_f32 v87, v87, s12, -v14
    v_exp_f32 v80, v80
    v_exp_f32 v81, v81
    v_exp_f32 v82, v82
    v_exp_f32 v83, v83
    v_exp_f32 v84, v84
    v_exp_f32 v85, v85
    v_exp_f32 v86, v86
    v_exp_f32 v87, v87
    v_cvt_pk_bf16_f32 v136, v80, v81
    v_cvt_pk_bf16_f32 v137, v82, v83
    v_cvt_pk_bf16_f32 v138, v84, v85
    v_cvt_pk_bf16_f32 v139, v86, v87
    ds_write_b128 v8, v[136:139] offset:3072
    v_add_f32 v13, v13, v80
    v_add_f32 v15, v15, v81
    v_add_f32 v13, v13, v82
    v_add_f32 v15, v15, v83
    v_add_f32 v13, v13, v84
    v_add_f32 v15, v15, v85
    v_add_f32 v13, v13, v86
    v_add_f32 v15, v15, v87
    v_fma_f32 v88, v88, s12, -v14
    v_fma_f32 v89, v89, s12, -v14
    v_fma_f32 v90, v90, s12, -v14
    v_fma_f32 v91, v91, s12, -v14
    v_fma_f32 v92, v92, s12, -v14
    v_fma_f32 v93, v93, s12, -v14
    v_fma_f32 v94, v94, s12, -v14
    v_fma_f32 v95, v95, s12, -v14
    v_exp_f32 v88, v88
    v_exp_f32 v89, v89
    v_exp_f32 v90, v90
    v_exp_f32 v91, v91
    v_exp_f32 v92, v92
    v_exp_f32 v93, v93
    v_exp_f32 v94, v94
    v_exp_f32 v95, v95
    v_cvt_pk_bf16_f32 v140, v88, v89
    v_cvt_pk_bf16_f32 v141, v90, v91
    v_cvt_pk_bf16_f32 v142, v92, v93
    v_cvt_pk_bf16_f32 v143, v94, v95
    ds_write_b128 v8, v[140:143] offset:4096
    v_add_f32 v13, v13, v88
    v_add_f32 v15, v15, v89
    v_add_f32 v13, v13, v90
    v_add_f32 v15, v15, v91
    v_add_f32 v13, v13, v92
    v_add_f32 v15, v15, v93
    v_add_f32 v13, v13, v94
    v_add_f32 v15, v15, v95
    v_fma_f32 v96, v96, s12, -v14
    v_fma_f32 v97, v97, s12, -v14
    v_fma_f32 v98, v98, s12, -v14
    v_fma_f32 v99, v99, s12, -v14
    v_fma_f32 v100, v100, s12, -v14
    v_fma_f32 v101, v101, s12, -v14
    v_fma_f32 v102, v102, s12, -v14
    v_fma_f32 v103, v103, s12, -v14
    v_exp_f32 v96, v96
    v_exp_f32 v97, v97
    v_exp_f32 v98, v98
    v_exp_f32 v99, v99
    v_exp_f32 v100, v100
    v_exp_f32 v101, v101
    v_exp_f32 v102, v102
    v_exp_f32 v103, v103
    v_cvt_pk_bf16_f32 v144, v96, v97
    v_cvt_pk_bf16_f32 v145, v98, v99
    v_cvt_pk_bf16_f32 v146, v100, v101
    v_cvt_pk_bf16_f32 v147, v102, v103
    ds_write_b128 v8, v[144:147] offset:5120
    v_add_f32 v13, v13, v96
    v_add_f32 v15, v15, v97
    v_add_f32 v13, v13, v98
    v_add_f32 v15, v15, v99
    v_add_f32 v13, v13, v100
    v_add_f32 v15, v15, v101
    v_add_f32 v13, v13, v102
    v_add_f32 v15, v15, v103
    v_fma_f32 v104, v104, s12, -v14
    v_fma_f32 v105, v105, s12, -v14
    v_fma_f32 v106, v106, s12, -v14
    v_fma_f32 v107, v107, s12, -v14
    v_fma_f32 v108, v108, s12, -v14
    v_fma_f32 v109, v109, s12, -v14
    v_fma_f32 v110, v110, s12, -v14
    v_fma_f32 v111, v111, s12, -v14
    v_exp_f32 v104, v104
    v_exp_f32 v105, v105
    v_exp_f32 v106, v106
    v_exp_f32 v107, v107
    v_exp_f32 v108, v108
    v_exp_f32 v109, v109
    v_exp_f32 v110, v110
    v_exp_f32 v111, v111
    v_cvt_pk_bf16_f32 v148, v104, v105
    v_cvt_pk_bf16_f32 v149, v106, v107
    v_cvt_pk_bf16_f32 v150, v108, v109
    v_cvt_pk_bf16_f32 v151, v110, v111
    ds_write_b128 v8, v[148:151] offset:6144
    v_add_f32 v13, v13, v104
    v_add_f32 v15, v15, v105
    v_add_f32 v13, v13, v106
    v_add_f32 v15, v15, v107
    v_add_f32 v13, v13, v108
    v_add_f32 v15, v15, v109
    v_add_f32 v13, v13, v110
    v_add_f32 v15, v15, v111
    v_fma_f32 v112, v112, s12, -v14
    v_fma_f32 v113, v113, s12, -v14
    v_fma_f32 v114, v114, s12, -v14
    v_fma_f32 v115, v115, s12, -v14
    v_fma_f32 v116, v116, s12, -v14
    v_fma_f32 v117, v117, s12, -v14
    v_fma_f32 v118, v118, s12, -v14
    v_fma_f32 v119, v119, s12, -v14
    v_exp_f32 v112, v112
    v_exp_f32 v113, v113
    v_exp_f32 v114, v114
    v_exp_f32 v115, v115
    v_exp_f32 v116, v116
    v_exp_f32 v117, v117
    v_exp_f32 v118, v118
    v_exp_f32 v119, v119
    v_cvt_pk_bf16_f32 v152, v112, v113
    v_cvt_pk_bf16_f32 v153, v114, v115
    v_cvt_pk_bf16_f32 v154, v116, v117
    v_cvt_pk_bf16_f32 v155, v118, v119
    ds_write_b128 v8, v[152:155] offset:7168
    v_add_f32 v13, v13, v112
    v_add_f32 v15, v15, v113
    v_add_f32 v13, v13, v114
    v_add_f32 v15, v15, v115
    v_add_f32 v13, v13, v116
    v_add_f32 v15, v15, v117
    v_add_f32 v13, v13, v118
    v_add_f32 v15, v15, v119
    v_fma_f32 v120, v120, s12, -v14
    v_fma_f32 v121, v121, s12, -v14
    v_fma_f32 v122, v122, s12, -v14
    v_fma_f32 v123, v123, s12, -v14
    v_fma_f32 v124, v124, s12, -v14
    v_fma_f32 v125, v125, s12, -v14
    v_fma_f32 v126, v126, s12, -v14
    v_fma_f32 v127, v127, s12, -v14
    v_exp_f32 v120, v120
    v_exp_f32 v121, v121
    v_exp_f32 v122, v122
    v_exp_f32 v123, v123
    v_exp_f32 v124, v124
    v_exp_f32 v125, v125
    v_exp_f32 v126, v126
    v_exp_f32 v127, v127
    v_cvt_pk_bf16_f32 v156, v120, v121
    v_cvt_pk_bf16_f32 v157, v122, v123
    v_cvt_pk_bf16_f32 v158, v124, v125
    v_cvt_pk_bf16_f32 v159, v126, v127
    ds_write_b128 v8, v[156:159] offset:8192
    v_add_f32 v13, v13, v120
    v_add_f32 v15, v15, v121
    v_add_f32 v13, v13, v122
    v_add_f32 v15, v15, v123
    v_add_f32 v13, v13, v124
    v_add_f32 v15, v15, v125
    v_add_f32 v13, v13, v126
    v_add_f32 v15, v15, v127
    v_mov_b32 v11, 1
    ds_write_b32 v1, v11 offset:36
    v_add_f32 v13, v13, v15
    s_nop 1
    v_add_f32_dpp v13, v13, v13 row_ror:1 row_mask:0xf bank_mask:0xf
    s_nop 1
    v_add_f32_dpp v13, v13, v13 row_ror:2 row_mask:0xf bank_mask:0xf
    s_nop 1
    v_add_f32_dpp v13, v13, v13 row_ror:4 row_mask:0xf bank_mask:0xf
    s_nop 1
    v_add_f32_dpp v13, v13, v13 row_ror:8 row_mask:0xf bank_mask:0xf
    v_mov_b32 v15, v13
    s_nop 1
    v_permlane16_swap_b32 v13, v15
    s_nop 1
    v_add_f32 v13, v13, v15
    v_mov_b32 v15, v13
    s_nop 1
    v_permlane32_swap_b32 v13, v15
    s_nop 1
    v_add_f32 v13, v13, v15
    s_lshl_b32 s62, s4, 10
    s_add_u32 s62, s62, 131072
    s_lshl_b32 s63, s5, 7
    s_add_u32 s63, s63, s62
    v_lshl_add_u32 v11, v0, 4, s63
    s_mov_b32 s7, 1
    v_min_u32 v24, -2, v12
    v_min_u32 v25, -2, v13
    v_mov_b32 v26, s7
    v_mov_b32 v27, 0
    v_and_b32 v15, 7, v0
    v_lshl_add_u32 v15, v15, 7, s62
    s_mov_b64 exec, 0xff
    global_store_dwordx4 v11, v[24:27], s[40:41] sc1
    s_mov_b64 exec, -1
    s_mov_b32 s60, 0
L_w_49:
    ds_read_b32 v18, v1 offset:0
    s_waitcnt lgkmcnt(0)
    v_readfirstlane_b32 s61, v18
    s_cmp_ge_i32 s61, 312
    s_cbranch_scc1 L_d_50
    s_sleep 8
    s_add_u32 s60, s60, 1
    s_cmp_lt_u32 s60, 1000000
    s_cbranch_scc1 L_w_49
    s_endpgm
L_padE_2:
    s_branch L_padE_3
L_d_50:
    s_mov_b32 s60, 0
L_ml_47:
    global_load_dwordx3 v[18:20], v15, s[40:41] sc1
    s_waitcnt vmcnt(0)
    v_max3_u32 v21, v18, v19, v20
    v_cmp_eq_u32 vcc, -1, v21
    s_cbranch_vccz L_mld_48
    s_sleep 16
    s_add_u32 s60, s60, 1
    s_cmp_lt_u32 s60, 1000000
    s_cbranch_scc1 L_ml_47
    s_endpgm
L_padE_3:
    s_branch L_padE_4
L_mld_48:
    v_mov_b32 v20, v18
    s_nop 1
    v_max_f32_dpp v20, v20, v20 row_ror:1 row_mask:0xf bank_mask:0xf
    s_nop 1
    v_max_f32_dpp v20, v20, v20 row_ror:2 row_mask:0xf bank_mask:0xf
    s_nop 1
    v_max_f32_dpp v20, v20, v20 row_ror:4 row_mask:0xf bank_mask:0xf
    v_sub_f32 v21, v18, v20
    v_sub_f32 v22, v12, v20
    v_mul_f32 v21, s12, v21
    v_mul_f32 v22, s12, v22
    v_exp_f32 v21, v21
    v_exp_f32 v22, v22
    s_nop 0
    v_mul_f32 v21, v21, v19
    s_nop 1
    v_add_f32_dpp v21, v21, v21 row_ror:1 row_mask:0xf bank_mask:0xf
    s_nop 1
    v_add_f32_dpp v21, v21, v21 row_ror:2 row_mask:0xf bank_mask:0xf
    s_nop 1
    v_add_f32_dpp v21, v21, v21 row_ror:4 row_mask:0xf bank_mask:0xf
    v_rcp_f32 v21, v21
    v_mov_b32 v11, s7
    v_mul_f32 v22, v22, v21
    v_mul_f32 v22, v22, v2
    ds_write_b32 v1, v22 offset:44
    ds_write_b32 v1, v11 offset:40
    s_cmp_lt_u32 s42, 28
    s_cbranch_scc0 L_end
    v_lshrrev_b32 v10, 3, v0
    v_lshlrev_b32 v10, 13, v10
    v_and_b32 v23, 7, v0
    v_lshl_add_u32 v10, v23, 4, v10
    s_lshl_b32 s56, s42, 16
    s_lshl_b32 s57, s5, 7
    s_add_u32 s56, s56, s57
    s_add_u32 s57, s56, 4096
    s_mov_b32 s60, 0
L_w_51:
    ds_read_b32 v18, v1 offset:0
    s_waitcnt lgkmcnt(0)
    v_readfirstlane_b32 s61, v18
    s_cmp_ge_i32 s61, 510
    s_cbranch_scc1 L_d_52
    s_sleep 1
    s_add_u32 s60, s60, 1
    s_cmp_lt_u32 s60, 1000000
    s_cbranch_scc1 L_w_51
    s_endpgm
L_padE_4:
    s_branch L_k_nb
L_d_52:
    buffer_load_dwordx4 v[192:195], v10, s[52:55], s56 offen offset:0 nt
    buffer_load_dwordx4 v[196:199], v10, s[52:55], s56 offen offset:1024 nt
    buffer_load_dwordx4 v[200:203], v10, s[52:55], s56 offen offset:2048 nt
    buffer_load_dwordx4 v[204:207], v10, s[52:55], s56 offen offset:3072 nt
    buffer_load_dwordx4 v[208:211], v10, s[52:55], s57 offen offset:0 nt
    buffer_load_dwordx4 v[212:215], v10, s[52:55], s57 offen offset:1024 nt
    buffer_load_dwordx4 v[216:219], v10, s[52:55], s57 offen offset:2048 nt
    buffer_load_dwordx4 v[220:223], v10, s[52:55], s57 offen offset:3072 nt
    s_waitcnt vmcnt(7)
    v_mfma_f32_16x16x32_bf16 v[4:7], v[160:163], v[192:195], 0
    s_waitcnt vmcnt(6)
    v_mfma_f32_16x16x32_bf16 v[4:7], v[164:167], v[196:199], v[4:7]
    s_waitcnt vmcnt(5)
    v_mfma_f32_16x16x32_bf16 v[4:7], v[168:171], v[200:203], v[4:7]
    s_waitcnt vmcnt(4)
    v_mfma_f32_16x16x32_bf16 v[4:7], v[172:175], v[204:207], v[4:7]
    s_waitcnt vmcnt(3)
    v_mfma_f32_16x16x32_bf16 v[4:7], v[176:179], v[208:211], v[4:7]
    s_waitcnt vmcnt(2)
    v_mfma_f32_16x16x32_bf16 v[4:7], v[180:183], v[212:215], v[4:7]
    s_waitcnt vmcnt(1)
    v_mfma_f32_16x16x32_bf16 v[4:7], v[184:187], v[216:219], v[4:7]
    s_waitcnt vmcnt(0)
    v_mfma_f32_16x16x32_bf16 v[4:7], v[188:191], v[220:223], v[4:7]
    s_nop 7
    v_permlane32_swap_b32 v4, v16
    v_permlane32_swap_b32 v5, v17
    v_permlane32_swap_b32 v6, v18
    v_permlane32_swap_b32 v7, v19
    s_nop 1
    v_add_f32_dpp v4, v16, v4 row_ror:8 row_mask:0xf bank_mask:0xf
    v_add_f32_dpp v5, v17, v5 row_ror:8 row_mask:0xf bank_mask:0xf
    v_add_f32_dpp v6, v18, v6 row_ror:8 row_mask:0xf bank_mask:0xf
    v_add_f32_dpp v7, v19, v7 row_ror:8 row_mask:0xf bank_mask:0xf
    v_mul_f32 v4, v4, v3
    v_mul_f32 v5, v5, v3
    v_mul_f32 v6, v6, v3
    v_mul_f32 v7, v7, v3
    v_min_u32 v4, -2, v4
    v_min_u32 v5, -2, v5
    v_min_u32 v6, -2, v6
    v_min_u32 v7, -2, v7
    s_mov_b64 exec, 0x00ff00ff
    ds_write_b128 v224, v[4:7] offset:640
L_end:
L_exit:
    s_endpgm
.section .rodata,"a"
.p2align 6
.amdhsa_kernel gated_mix__mha_block_cached__glu_gated_swiglu__decode_kernel
  .amdhsa_next_free_vgpr 256
  .amdhsa_next_free_sgpr 102
  .amdhsa_accum_offset 256
  .amdhsa_group_segment_fixed_size 0
  .amdhsa_kernarg_size 104
  .amdhsa_user_sgpr_count 2
  .amdhsa_user_sgpr_kernarg_segment_ptr 1
  .amdhsa_system_sgpr_workgroup_id_x 1
  .amdhsa_float_denorm_mode_32 3
.end_amdhsa_kernel
```
